```python
import torch

def _softmax(x, axis=-1):
    return torch.softmax(x, dim=axis)
def _gelu(x):
    return torch.nn.functional.gelu(x, approximate="tanh")
def _silu(x):
    return torch.nn.functional.silu(x)
def _sigmoid(x):
    return torch.sigmoid(x)
def _layernorm(x, axis=-1, eps=1e-5):
    m = x.mean(dim=axis, keepdim=True)
    v = x.var(dim=axis, keepdim=True, unbiased=False)
    return (x - m) / torch.sqrt(v + eps)
def _scatter_add(tgt, idx, src, axis=0):
    return tgt.clone().index_add_(axis, idx, src)
def _segment_sum(src, seg, n):
    out = torch.zeros((n,) + src.shape[1:], dtype=src.dtype)
    return out.index_add_(0, seg, src)
def _pad(x, pw):
    flat = tuple(v for pair in reversed(pw) for v in pair)
    return torch.nn.functional.pad(x, flat)

kernel_name = 'concat_heads__sliding_block_cached__mha_block_cached__decode'

def setup_inputs():

    _w = (lambda a: (lambda t: t.to(torch.bfloat16) if t.is_floating_point() else t)(torch.as_tensor(a)))
    def _A_setup():
        B, Sq, D = 2, 1, 576
        Hq, Hkv, Sk, Dh = 32, 16, 8192, 128
        assert Hq % Hkv == 0, (Hq, Hkv)
        return {
            "x": _w((lambda *s: torch.randn(*s, dtype=torch.bfloat16) * 0.8)(B, Sq, D)),
            "k_cache": _w((lambda *s: torch.randn(*s, dtype=torch.bfloat16) * 1.6)(B, Hkv, Sk, Dh)),
            "v_cache": _w((lambda *s: torch.randn(*s, dtype=torch.bfloat16) * 0.2)(B, Hkv, Sk, Dh)),
            "wq": _w((lambda *s: torch.randn(*s, dtype=torch.bfloat16) * 1.6)(D, Hq * Dh) * (D ** -0.5)),
            "wo": _w((lambda *s: torch.randn(*s, dtype=torch.bfloat16) * 0.2)(Hq * Dh, D) * ((Hq * Dh) ** -0.5)),
        }
    _A_in = _A_setup()

    def _B_setup():
        B, Sq, D = 2, 1, 576
        H, Sk, Dh = 32, 8192, 128
        return {
            "x": _w((lambda *s: torch.randn(*s, dtype=torch.bfloat16) * 0.8)(B, Sq, D)),
            "k_cache": _w((lambda *s: torch.randn(*s, dtype=torch.bfloat16) * 1.6)(B, H, Sk, Dh)),
            "v_cache": _w((lambda *s: torch.randn(*s, dtype=torch.bfloat16) * 0.2)(B, H, Sk, Dh)),
            "wq": _w((lambda *s: torch.randn(*s, dtype=torch.bfloat16) * 1.6)(D, H * Dh) * (D ** -0.5)),
            "wo": _w((lambda *s: torch.randn(*s, dtype=torch.bfloat16) * 0.2)(H * Dh, D) * ((H * Dh) ** -0.5)),
        }
    _B_in = _B_setup()

    return {
        "A_x": _A_in["x"],
        "A_k_cache": _A_in["k_cache"],
        "A_v_cache": _A_in["v_cache"],
        "A_wq": _A_in["wq"],
        "A_wo": _A_in["wo"],
        "B_x": _B_in["x"],
        "B_k_cache": _B_in["k_cache"],
        "B_v_cache": _B_in["v_cache"],
        "B_wq": _B_in["wq"],
        "B_wo": _B_in["wo"],
    }

def reference(A_x, A_k_cache, A_v_cache, A_wq, A_wo, B_x, B_k_cache, B_v_cache, B_wq, B_wo):
    def _A_ref(x, k_cache, v_cache, wq, wo):
        B, Sq, D = x.shape
        Hq, Dh = 32, 128
        Hkv, Sk = k_cache.shape[1], k_cache.shape[2]
        W = min(4096, max(256, Sk // 4))
        rep = Hq // Hkv
        q = (lambda x, *d: x.permute(*d))((x @ wq).reshape(B, Sq, Hq, Dh), 0, 2, 1, 3)
        k = (lambda x, n, axis: torch.repeat_interleave(x, n, dim=axis))(k_cache[:, :, Sk - W:, :], rep, axis=1)
        v = (lambda x, n, axis: torch.repeat_interleave(x, n, dim=axis))(v_cache[:, :, Sk - W:, :], rep, axis=1)
        scores = torch.einsum("bhqd,bhkd->bhqk", q, k) * (Dh ** -0.5)
        p = _softmax(scores, axis=-1)
        o = torch.einsum("bhqk,bhkd->bhqd", p, v)
        return (lambda x, *d: x.permute(*d))(o, 0, 2, 1, 3).reshape(B, Sq, Hq * Dh) @ wo

    def _B_ref(x, k_cache, v_cache, wq, wo):
        B, Sq, D = x.shape
        H, Dh = 32, 128
        q = (lambda x, *d: x.permute(*d))((x @ wq).reshape(B, Sq, H, Dh), 0, 2, 1, 3)
        scores = torch.einsum("bhqd,bhkd->bhqk", q, k_cache) * (Dh ** -0.5)
        p = _softmax(scores, axis=-1)
        o = torch.einsum("bhqk,bhkd->bhqd", p, v_cache)
        return (lambda x, *d: x.permute(*d))(o, 0, 2, 1, 3).reshape(B, Sq, H * Dh) @ wo

    a = _A_ref(A_x, A_k_cache, A_v_cache, A_wq, A_wo)
    b = _B_ref(B_x, B_k_cache, B_v_cache, B_wq, B_wo)
    return torch.concatenate([a, b], axis=-1)
```

```asm
; @launch grid=(256,1,1) block=(256,1,1) lds=163264
.amdgcn_target "amdgcn-amd-amdhsa--gfx950"
.text
.globl concat_heads__sliding_block_cached__mha_block_cached__decode_kernel
.p2align 8
.type concat_heads__sliding_block_cached__mha_block_cached__decode_kernel,@function
concat_heads__sliding_block_cached__mha_block_cached__decode_kernel:
    s_cmp_ge_u32 s2, 256
    s_cbranch_scc1 L_exit
    s_memrealtime s[94:95]
    s_load_dwordx16 s[8:23], s[0:1], 0
    s_load_dwordx8 s[24:31], s[0:1], 64
    s_load_dwordx2 s[32:33], s[0:1], 96
    v_lshrrev_b32 v10, 6, v0
    v_mov_b32 v11, 151936
    v_mov_b32 v32, 0
    v_mov_b32 v33, 0
    v_mov_b32 v34, 0
    v_mov_b32 v35, 0
    v_readfirstlane_b32 s3, v10
    ds_write_b128 v11, v[32:35]
    v_and_b32 v1, 63, v0
    v_bfe_u32 v2, v0, 4, 2
    v_and_b32 v3, 15, v0
    s_and_b32 s62, s2, 3
    s_mul_i32 s63, s62, 144
    v_mad_u32_u24 v25, v2, 36, s63
    s_bfe_u32 s63, s2, 0x50002
    s_lshl_b32 s64, s63, 8
    v_lshl_add_u32 v24, v3, 4, s64
    v_lshl_add_u32 v24, v25, 13, v24
    v_lshrrev_b32 v10, 3, v3
    v_mul_u32_u24 v10, 1152, v10
    v_lshl_add_u32 v25, v25, 1, v10
    s_lshr_b32 s99, s2, 7
    s_mov_b32 s46, 4718592
    s_mov_b32 s47, 0x00020000
    s_mov_b32 s50, 2304
    s_mov_b32 s51, 0x00020000
    s_mov_b32 s58, 4718592
    s_mov_b32 s59, 0x00020000
    s_cmp_eq_u32 s99, 0
    s_waitcnt lgkmcnt(0)
    s_cselect_b64 s[44:45], s[14:15], s[24:25]
    s_cselect_b64 s[48:49], s[8:9], s[18:19]
    s_load_dword s6, s[32:33], 0
    s_cmp_lg_u32 s3, 3
    s_cbranch_scc1 L_nq0
    buffer_load_dwordx4 v[96:99], v25, s[48:51], 0 offen offset:0
    buffer_load_dwordx4 v[100:103], v25, s[48:51], 0 offen offset:16
    buffer_load_dwordx4 v[104:107], v25, s[48:51], 0 offen offset:32
    buffer_load_dwordx4 v[108:111], v25, s[48:51], 0 offen offset:48
    buffer_load_dwordx2 v[112:113], v25, s[48:51], 0 offen offset:64
    buffer_load_dwordx4 a[0:3], v24, s[44:47], 0 offen nt
    s_mov_b32 s34, 8192
    buffer_load_dwordx4 a[4:7], v24, s[44:47], s34 offen nt
    s_mov_b32 s34, 16384
    buffer_load_dwordx4 a[8:11], v24, s[44:47], s34 offen nt
    s_mov_b32 s34, 24576
    buffer_load_dwordx4 a[12:15], v24, s[44:47], s34 offen nt
    s_mov_b32 s34, 32768
    buffer_load_dwordx4 a[16:19], v24, s[44:47], s34 offen nt
    s_mov_b32 s34, 40960
    buffer_load_dwordx4 a[20:23], v24, s[44:47], s34 offen nt
    s_mov_b32 s34, 49152
    buffer_load_dwordx4 a[24:27], v24, s[44:47], s34 offen nt
    s_mov_b32 s34, 57344
    buffer_load_dwordx4 a[28:31], v24, s[44:47], s34 offen nt
    s_mov_b32 s34, 65536
    buffer_load_dwordx4 a[32:35], v24, s[44:47], s34 offen nt
    s_mov_b32 s34, 73728
    buffer_load_dwordx4 a[36:39], v24, s[44:47], s34 offen nt
    s_mov_b32 s34, 81920
    buffer_load_dwordx4 a[40:43], v24, s[44:47], s34 offen nt
    s_mov_b32 s34, 90112
    buffer_load_dwordx4 a[44:47], v24, s[44:47], s34 offen nt
    s_mov_b32 s34, 98304
    buffer_load_dwordx4 a[48:51], v24, s[44:47], s34 offen nt
    s_mov_b32 s34, 106496
    buffer_load_dwordx4 a[52:55], v24, s[44:47], s34 offen nt
    s_mov_b32 s34, 114688
    buffer_load_dwordx4 a[56:59], v24, s[44:47], s34 offen nt
    s_mov_b32 s34, 122880
    buffer_load_dwordx4 a[60:63], v24, s[44:47], s34 offen nt
    s_barrier
    s_mov_b32 s34, 131072
    buffer_load_dwordx4 a[64:67], v24, s[44:47], s34 offen nt
    s_mov_b32 s34, 139264
    buffer_load_dwordx4 a[68:71], v24, s[44:47], s34 offen nt
    s_mov_b32 s34, 147456
    buffer_load_dwordx4 a[72:75], v24, s[44:47], s34 offen nt
    s_mov_b32 s34, 155648
    buffer_load_dwordx4 a[76:79], v24, s[44:47], s34 offen nt
    s_mov_b32 s34, 163840
    buffer_load_dwordx4 a[80:83], v24, s[44:47], s34 offen nt
    s_mov_b32 s34, 172032
    buffer_load_dwordx4 a[84:87], v24, s[44:47], s34 offen nt
    s_mov_b32 s34, 180224
    buffer_load_dwordx4 a[88:91], v24, s[44:47], s34 offen nt
    s_mov_b32 s34, 188416
    buffer_load_dwordx4 a[92:95], v24, s[44:47], s34 offen nt
    s_mov_b32 s34, 196608
    buffer_load_dwordx4 a[96:99], v24, s[44:47], s34 offen nt
    s_mov_b32 s34, 204800
    buffer_load_dwordx4 a[100:103], v24, s[44:47], s34 offen nt
    s_mov_b32 s34, 212992
    buffer_load_dwordx4 a[104:107], v24, s[44:47], s34 offen nt
    s_mov_b32 s34, 221184
    buffer_load_dwordx4 a[108:111], v24, s[44:47], s34 offen nt
    s_mov_b32 s34, 229376
    buffer_load_dwordx4 a[112:115], v24, s[44:47], s34 offen nt
    s_mov_b32 s34, 237568
    buffer_load_dwordx4 a[116:119], v24, s[44:47], s34 offen nt
    s_mov_b32 s34, 245760
    buffer_load_dwordx4 a[120:123], v24, s[44:47], s34 offen nt
    s_mov_b32 s34, 253952
    buffer_load_dwordx4 a[124:127], v24, s[44:47], s34 offen nt
    s_mov_b32 s34, 262144
    buffer_load_dwordx4 a[128:131], v24, s[44:47], s34 offen nt
    s_mov_b32 s34, 270336
    buffer_load_dwordx4 a[132:135], v24, s[44:47], s34 offen nt
    s_mov_b32 s34, 278528
    buffer_load_dwordx4 a[136:139], v24, s[44:47], s34 offen nt
    s_mov_b32 s34, 286720
    buffer_load_dwordx4 a[140:143], v24, s[44:47], s34 offen nt
    s_branch L_nq1
L_nq0:
    s_barrier
L_nq1:
    s_mov_b32 s56, s32
    s_mov_b32 s57, s33
    v_and_b32 v10, 1, v1
    v_lshlrev_b32 v10, 4, v10
    v_mov_b32 v11, 0xffff
    v_lshlrev_b32 v10, v10, v11
    v_bfe_u32 v11, v1, 1, 2
    v_cmp_eq_u32 vcc, 0, v11
    v_cndmask_b32 v20, 0, v10, vcc
    v_cmp_eq_u32 vcc, 1, v11
    v_cndmask_b32 v21, 0, v10, vcc
    v_cmp_eq_u32 vcc, 2, v11
    v_cndmask_b32 v22, 0, v10, vcc
    v_cmp_eq_u32 vcc, 3, v11
    v_cndmask_b32 v23, 0, v10, vcc
    s_cbranch_scc1 L_nq2
    s_lshl3_add_u32 s62, s99, s62
    s_lshl_b32 s62, s62, 15
    s_lshl_b32 s63, s63, 10
    s_add_u32 s62, s62, s63
    s_add_u32 s62, s62, 4194304
    v_and_b32 v10, 31, v1
    v_lshl_add_u32 v26, v10, 4, s62
    v_lshrrev_b32 v10, 5, v1
    v_lshl_add_u32 v26, v10, 17, v26
    s_mov_b32 s69, 0x01000100
    s_mov_b32 s70, 0x03020302
    s_waitcnt lgkmcnt(0)
    s_add_u32 s64, s6, 1
    s_mul_i32 s7, s64, 0x9E3779B1
    s_or_b32 s7, s7, 1
    s_cmp_gt_u32 s2, 7
    s_cbranch_scc1 L_nq3
    s_mov_b32 s64, s94
    s_xor_b32 s62, s64, s7
    v_mov_b32 v16, s64
    v_mov_b32 v17, s62
    v_lshlrev_b32 v10, 7, v3
    s_lshl3_add_u32 s62, s2, 395264
    s_mov_b64 exec, 0xffff
    buffer_store_dwordx2 v[16:17], v10, s[56:59], s62 offen sc1
    s_mov_b64 exec, -1
L_nq3:
    s_waitcnt vmcnt(36)
    v_perm_b32 v124, v96, v96, s69
    v_and_b32 v120, v124, v20
    v_and_b32 v121, v124, v21
    v_and_b32 v122, v124, v22
    v_and_b32 v123, v124, v23
    v_perm_b32 v132, v96, v96, s70
    v_and_b32 v128, v132, v20
    v_and_b32 v129, v132, v21
    v_and_b32 v130, v132, v22
    v_and_b32 v131, v132, v23
    s_waitcnt vmcnt(35)
    v_mfma_f32_16x16x32_bf16 v[64:67], v[120:123], a[0:3], 0
    v_perm_b32 v140, v97, v97, s69
    v_and_b32 v136, v140, v20
    v_and_b32 v137, v140, v21
    v_and_b32 v138, v140, v22
    v_and_b32 v139, v140, v23
    s_waitcnt vmcnt(34)
    v_mfma_f32_16x16x32_bf16 v[68:71], v[128:131], a[4:7], 0
    v_perm_b32 v148, v97, v97, s70
    v_and_b32 v144, v148, v20
    v_and_b32 v145, v148, v21
    v_and_b32 v146, v148, v22
    v_and_b32 v147, v148, v23
    s_waitcnt vmcnt(33)
    v_mfma_f32_16x16x32_bf16 v[64:67], v[136:139], a[8:11], v[64:67]
    v_perm_b32 v124, v98, v98, s69
    v_and_b32 v120, v124, v20
    v_and_b32 v121, v124, v21
    v_and_b32 v122, v124, v22
    v_and_b32 v123, v124, v23
    s_waitcnt vmcnt(32)
    v_mfma_f32_16x16x32_bf16 v[68:71], v[144:147], a[12:15], v[68:71]
    v_perm_b32 v132, v98, v98, s70
    v_and_b32 v128, v132, v20
    v_and_b32 v129, v132, v21
    v_and_b32 v130, v132, v22
    v_and_b32 v131, v132, v23
    s_waitcnt vmcnt(31)
    v_mfma_f32_16x16x32_bf16 v[64:67], v[120:123], a[16:19], v[64:67]
    v_perm_b32 v140, v99, v99, s69
    v_and_b32 v136, v140, v20
    v_and_b32 v137, v140, v21
    v_and_b32 v138, v140, v22
    v_and_b32 v139, v140, v23
    s_waitcnt vmcnt(30)
    v_mfma_f32_16x16x32_bf16 v[68:71], v[128:131], a[20:23], v[68:71]
    v_perm_b32 v148, v99, v99, s70
    v_and_b32 v144, v148, v20
    v_and_b32 v145, v148, v21
    v_and_b32 v146, v148, v22
    v_and_b32 v147, v148, v23
    s_waitcnt vmcnt(29)
    v_mfma_f32_16x16x32_bf16 v[64:67], v[136:139], a[24:27], v[64:67]
    v_perm_b32 v124, v100, v100, s69
    v_and_b32 v120, v124, v20
    v_and_b32 v121, v124, v21
    v_and_b32 v122, v124, v22
    v_and_b32 v123, v124, v23
    s_waitcnt vmcnt(28)
    v_mfma_f32_16x16x32_bf16 v[68:71], v[144:147], a[28:31], v[68:71]
    v_perm_b32 v132, v100, v100, s70
    v_and_b32 v128, v132, v20
    v_and_b32 v129, v132, v21
    v_and_b32 v130, v132, v22
    v_and_b32 v131, v132, v23
    s_waitcnt vmcnt(27)
    v_mfma_f32_16x16x32_bf16 v[64:67], v[120:123], a[32:35], v[64:67]
    v_perm_b32 v140, v101, v101, s69
    v_and_b32 v136, v140, v20
    v_and_b32 v137, v140, v21
    v_and_b32 v138, v140, v22
    v_and_b32 v139, v140, v23
    s_waitcnt vmcnt(26)
    v_mfma_f32_16x16x32_bf16 v[68:71], v[128:131], a[36:39], v[68:71]
    v_perm_b32 v148, v101, v101, s70
    v_and_b32 v144, v148, v20
    v_and_b32 v145, v148, v21
    v_and_b32 v146, v148, v22
    v_and_b32 v147, v148, v23
    s_waitcnt vmcnt(25)
    v_mfma_f32_16x16x32_bf16 v[64:67], v[136:139], a[40:43], v[64:67]
    v_perm_b32 v124, v102, v102, s69
    v_and_b32 v120, v124, v20
    v_and_b32 v121, v124, v21
    v_and_b32 v122, v124, v22
    v_and_b32 v123, v124, v23
    s_waitcnt vmcnt(24)
    v_mfma_f32_16x16x32_bf16 v[68:71], v[144:147], a[44:47], v[68:71]
    v_perm_b32 v132, v102, v102, s70
    v_and_b32 v128, v132, v20
    v_and_b32 v129, v132, v21
    v_and_b32 v130, v132, v22
    v_and_b32 v131, v132, v23
    s_waitcnt vmcnt(23)
    v_mfma_f32_16x16x32_bf16 v[64:67], v[120:123], a[48:51], v[64:67]
    v_perm_b32 v140, v103, v103, s69
    v_and_b32 v136, v140, v20
    v_and_b32 v137, v140, v21
    v_and_b32 v138, v140, v22
    v_and_b32 v139, v140, v23
    s_waitcnt vmcnt(22)
    v_mfma_f32_16x16x32_bf16 v[68:71], v[128:131], a[52:55], v[68:71]
    v_perm_b32 v148, v103, v103, s70
    v_and_b32 v144, v148, v20
    v_and_b32 v145, v148, v21
    v_and_b32 v146, v148, v22
    v_and_b32 v147, v148, v23
    s_waitcnt vmcnt(21)
    v_mfma_f32_16x16x32_bf16 v[64:67], v[136:139], a[56:59], v[64:67]
    v_perm_b32 v124, v104, v104, s69
    v_and_b32 v120, v124, v20
    v_and_b32 v121, v124, v21
    v_and_b32 v122, v124, v22
    v_and_b32 v123, v124, v23
    s_waitcnt vmcnt(20)
    v_mfma_f32_16x16x32_bf16 v[68:71], v[144:147], a[60:63], v[68:71]
    v_perm_b32 v132, v104, v104, s70
    v_and_b32 v128, v132, v20
    v_and_b32 v129, v132, v21
    v_and_b32 v130, v132, v22
    v_and_b32 v131, v132, v23
    s_waitcnt vmcnt(19)
    v_mfma_f32_16x16x32_bf16 v[64:67], v[120:123], a[64:67], v[64:67]
    v_perm_b32 v140, v105, v105, s69
    v_and_b32 v136, v140, v20
    v_and_b32 v137, v140, v21
    v_and_b32 v138, v140, v22
    v_and_b32 v139, v140, v23
    s_waitcnt vmcnt(18)
    v_mfma_f32_16x16x32_bf16 v[68:71], v[128:131], a[68:71], v[68:71]
    v_perm_b32 v148, v105, v105, s70
    v_and_b32 v144, v148, v20
    v_and_b32 v145, v148, v21
    v_and_b32 v146, v148, v22
    v_and_b32 v147, v148, v23
    s_waitcnt vmcnt(17)
    v_mfma_f32_16x16x32_bf16 v[64:67], v[136:139], a[72:75], v[64:67]
    v_perm_b32 v124, v106, v106, s69
    v_and_b32 v120, v124, v20
    v_and_b32 v121, v124, v21
    v_and_b32 v122, v124, v22
    v_and_b32 v123, v124, v23
    s_waitcnt vmcnt(16)
    v_mfma_f32_16x16x32_bf16 v[68:71], v[144:147], a[76:79], v[68:71]
    v_perm_b32 v132, v106, v106, s70
    v_and_b32 v128, v132, v20
    v_and_b32 v129, v132, v21
    v_and_b32 v130, v132, v22
    v_and_b32 v131, v132, v23
    s_waitcnt vmcnt(15)
    v_mfma_f32_16x16x32_bf16 v[64:67], v[120:123], a[80:83], v[64:67]
    v_perm_b32 v140, v107, v107, s69
    v_and_b32 v136, v140, v20
    v_and_b32 v137, v140, v21
    v_and_b32 v138, v140, v22
    v_and_b32 v139, v140, v23
    s_waitcnt vmcnt(14)
    v_mfma_f32_16x16x32_bf16 v[68:71], v[128:131], a[84:87], v[68:71]
    v_perm_b32 v148, v107, v107, s70
    v_and_b32 v144, v148, v20
    v_and_b32 v145, v148, v21
    v_and_b32 v146, v148, v22
    v_and_b32 v147, v148, v23
    s_waitcnt vmcnt(13)
    v_mfma_f32_16x16x32_bf16 v[64:67], v[136:139], a[88:91], v[64:67]
    v_perm_b32 v124, v108, v108, s69
    v_and_b32 v120, v124, v20
    v_and_b32 v121, v124, v21
    v_and_b32 v122, v124, v22
    v_and_b32 v123, v124, v23
    s_waitcnt vmcnt(12)
    v_mfma_f32_16x16x32_bf16 v[68:71], v[144:147], a[92:95], v[68:71]
    v_perm_b32 v132, v108, v108, s70
    v_and_b32 v128, v132, v20
    v_and_b32 v129, v132, v21
    v_and_b32 v130, v132, v22
    v_and_b32 v131, v132, v23
    s_waitcnt vmcnt(11)
    v_mfma_f32_16x16x32_bf16 v[64:67], v[120:123], a[96:99], v[64:67]
    v_perm_b32 v140, v109, v109, s69
    v_and_b32 v136, v140, v20
    v_and_b32 v137, v140, v21
    v_and_b32 v138, v140, v22
    v_and_b32 v139, v140, v23
    s_waitcnt vmcnt(10)
    v_mfma_f32_16x16x32_bf16 v[68:71], v[128:131], a[100:103], v[68:71]
    v_perm_b32 v148, v109, v109, s70
    v_and_b32 v144, v148, v20
    v_and_b32 v145, v148, v21
    v_and_b32 v146, v148, v22
    v_and_b32 v147, v148, v23
    s_waitcnt vmcnt(9)
    v_mfma_f32_16x16x32_bf16 v[64:67], v[136:139], a[104:107], v[64:67]
    v_perm_b32 v124, v110, v110, s69
    v_and_b32 v120, v124, v20
    v_and_b32 v121, v124, v21
    v_and_b32 v122, v124, v22
    v_and_b32 v123, v124, v23
    s_waitcnt vmcnt(8)
    v_mfma_f32_16x16x32_bf16 v[68:71], v[144:147], a[108:111], v[68:71]
    v_perm_b32 v132, v110, v110, s70
    v_and_b32 v128, v132, v20
    v_and_b32 v129, v132, v21
    v_and_b32 v130, v132, v22
    v_and_b32 v131, v132, v23
    s_waitcnt vmcnt(7)
    v_mfma_f32_16x16x32_bf16 v[64:67], v[120:123], a[112:115], v[64:67]
    v_perm_b32 v140, v111, v111, s69
    v_and_b32 v136, v140, v20
    v_and_b32 v137, v140, v21
    v_and_b32 v138, v140, v22
    v_and_b32 v139, v140, v23
    s_waitcnt vmcnt(6)
    v_mfma_f32_16x16x32_bf16 v[68:71], v[128:131], a[116:119], v[68:71]
    v_perm_b32 v148, v111, v111, s70
    v_and_b32 v144, v148, v20
    v_and_b32 v145, v148, v21
    v_and_b32 v146, v148, v22
    v_and_b32 v147, v148, v23
    s_waitcnt vmcnt(5)
    v_mfma_f32_16x16x32_bf16 v[64:67], v[136:139], a[120:123], v[64:67]
    v_perm_b32 v124, v112, v112, s69
    v_and_b32 v120, v124, v20
    v_and_b32 v121, v124, v21
    v_and_b32 v122, v124, v22
    v_and_b32 v123, v124, v23
    s_waitcnt vmcnt(4)
    v_mfma_f32_16x16x32_bf16 v[68:71], v[144:147], a[124:127], v[68:71]
    v_perm_b32 v132, v112, v112, s70
    v_and_b32 v128, v132, v20
    v_and_b32 v129, v132, v21
    v_and_b32 v130, v132, v22
    v_and_b32 v131, v132, v23
    s_waitcnt vmcnt(3)
    v_mfma_f32_16x16x32_bf16 v[64:67], v[120:123], a[128:131], v[64:67]
    v_perm_b32 v140, v113, v113, s69
    v_and_b32 v136, v140, v20
    v_and_b32 v137, v140, v21
    v_and_b32 v138, v140, v22
    v_and_b32 v139, v140, v23
    s_waitcnt vmcnt(2)
    v_mfma_f32_16x16x32_bf16 v[68:71], v[128:131], a[132:135], v[68:71]
    v_perm_b32 v148, v113, v113, s70
    v_and_b32 v144, v148, v20
    v_and_b32 v145, v148, v21
    v_and_b32 v146, v148, v22
    v_and_b32 v147, v148, v23
    s_waitcnt vmcnt(1)
    v_mfma_f32_16x16x32_bf16 v[64:67], v[136:139], a[136:139], v[64:67]
    s_waitcnt vmcnt(0)
    v_mfma_f32_16x16x32_bf16 v[68:71], v[144:147], a[140:143], v[68:71]
    s_nop 7
    s_nop 0
    v_add_f32 v64, v64, v68
    v_add_f32 v65, v65, v69
    v_add_f32 v66, v66, v70
    v_add_f32 v67, v67, v71
    v_xor_b32 v68, s7, v64
    v_xor_b32 v69, s7, v65
    v_xor_b32 v70, s7, v66
    v_xor_b32 v71, s7, v67
    buffer_store_dwordx4 v[64:67], v26, s[56:59], 0 offen sc1
    buffer_store_dwordx4 v[68:71], v26, s[56:59], 0 offen offset:512 sc1
L_nq2:
    v_and_b32 v4, 3, v3
    v_lshlrev_b32 v4, 4, v4
    v_lshl_add_u32 v4, v2, 6, v4
    v_lshrrev_b32 v10, 2, v3
    v_lshl_add_u32 v161, v10, 15, v4
    v_lshlrev_b32 v5, 4, v3
    v_bfe_u32 v11, v3, 2, 1
    v_lshl_add_u32 v4, v11, 15, v4
    v_bfe_u32 v11, v2, 0, 1
    v_lshl_add_u32 v5, v11, 15, v5
    v_bfe_u32 v11, v3, 3, 1
    v_lshl_add_u32 v4, v11, 9, v4
    v_bfe_u32 v11, v2, 1, 1
    v_lshl_add_u32 v5, v11, 9, v5
    s_and_b32 s62, s2, 7
    s_lshr_b32 s63, s2, 3
    s_bfe_u32 s64, s2, 0x10004
    s_lshl1_add_u32 s64, s62, s64
    s_bfe_u32 s65, s2, 0x10003
    s_lshl_b32 s100, s65, 17
    s_lshl_b32 s98, s64, 11
    s_add_u32 s100, s100, s98
    s_add_u32 s100, s100, 4194304
    s_lshl4_add_u32 s64, s65, s64
    s_lshl_b32 s98, s64, 21
    s_add_u32 s98, s98, 0x180000
    s_lshr_b32 s65, s2, 5
    s_lshl3_add_u32 s74, s64, s65
    s_mul_i32 s61, s64, 25
    s_lshl4_add_u32 s61, s65, s61
    s_add_u32 s61, s61, s3
    s_add_u32 s44, s10, s98
    s_addc_u32 s45, s11, 0
    s_add_u32 s48, s12, s98
    s_addc_u32 s49, s13, 0
    s_mov_b32 s46, 0x80000
    s_mov_b32 s50, 0x80000
    s_cmp_ge_u32 s63, 24
    s_cbranch_scc1 L_setH
    s_add_u32 s96, s61, 0
    s_bfe_u32 s66, s96, 262144
    s_lshl_b32 s66, s66, 11
    s_bfe_u32 s34, s96, 327684
    s_lshl_b32 s34, s34, 16
    s_or_b32 s66, s66, s34
    s_and_b32 s66, s66, 524287
    buffer_load_dwordx4 a[64:67], v4, s[44:47], s66 offen offset:0 nt
    buffer_load_dwordx4 a[68:71], v4, s[44:47], s66 offen offset:256 nt
    buffer_load_dwordx4 a[72:75], v4, s[44:47], s66 offen offset:1024 nt
    buffer_load_dwordx4 a[76:79], v4, s[44:47], s66 offen offset:1280 nt
    s_add_u32 s96, s61, 4
    s_bfe_u32 s66, s96, 262144
    s_lshl_b32 s66, s66, 11
    s_bfe_u32 s34, s96, 327684
    s_lshl_b32 s34, s34, 16
    s_or_b32 s66, s66, s34
    s_and_b32 s66, s66, 524287
    buffer_load_dwordx4 a[80:83], v4, s[44:47], s66 offen offset:0 nt
    buffer_load_dwordx4 a[84:87], v4, s[44:47], s66 offen offset:256 nt
    buffer_load_dwordx4 a[88:91], v4, s[44:47], s66 offen offset:1024 nt
    buffer_load_dwordx4 a[92:95], v4, s[44:47], s66 offen offset:1280 nt
    s_mov_b32 s76, 0
    s_mul_i32 s64, s63, 171
    s_lshr_b32 s64, s64, 9
    s_mul_i32 s65, s64, 3
    s_sub_u32 s63, s63, s65
    s_mul_i32 s60, s64, 64
    s_mul_i32 s65, s62, 11
    s_add_u32 s60, s60, s65
    s_lshr_b32 s65, s64, 1
    s_lshl2_add_u32 s62, s62, s65
    s_and_b32 s64, s64, 1
    s_lshl_b32 s75, s64, 17
    s_lshl_b32 s65, s62, 10
    s_add_u32 s75, s75, s65
    s_add_u32 s75, s75, 4456448
    s_lshl_b32 s64, s64, 5
    s_add_u32 s64, s64, s62
    s_lshl_b32 s96, s64, 21
    s_mul_i32 s73, s64, 3
    s_add_u32 s73, s73, s63
    s_cmp_eq_u32 s63, 1
    s_cselect_b32 s67, 171, 0
    s_cselect_b32 s78, 342, 0
    s_cmp_eq_u32 s63, 0
    s_cselect_b32 s78, 171, s78
    s_cmp_eq_u32 s63, 2
    s_cselect_b32 s67, 342, s67
    s_cselect_b32 s78, 512, s78
    s_branch L_common
L_setH:
    s_mov_b32 s76, 1
    s_bfe_u32 s64, s2, 0x20004
    s_lshl2_add_u32 s62, s62, s64
    s_bfe_u32 s64, s2, 0x10003
    s_lshl_b32 s64, s64, 5
    s_add_u32 s67, s64, s62
    s_add_u32 s73, s67, 192
    s_lshl_b32 s96, s67, 21
    s_mov_b32 s60, 0
L_common:
    s_mul_i32 s97, s62, 147456
    s_mul_i32 s62, s73, 1536
    s_add_u32 s62, s62, 2048
    s_mul_i32 s64, s3, 384
    s_add_u32 s62, s62, s64
    v_mov_b32 v6, 1073741824
    v_mov_b32 v7, 1073741824
    s_mov_b64 exec, 16777215
    v_lshl_add_u32 v6, v1, 4, s62
    s_mov_b64 exec, 0xff
    v_mov_b32 v7, v6
    s_mov_b64 exec, -1
    s_add_u32 s36, s20, s96
    s_addc_u32 s37, s21, 0
    s_add_u32 s40, s22, s96
    s_addc_u32 s41, s23, 0
    s_mov_b32 s38, 2097152
    s_mov_b32 s39, 0x00020000
    s_mov_b32 s42, 2097152
    s_mov_b32 s43, 0x00020000
    s_cmp_eq_u32 s76, 1
    s_cselect_b64 s[52:53], s[16:17], s[26:27]
    s_add_u32 s52, s52, s97
    s_addc_u32 s53, s53, 0
    s_mov_b32 s54, 147456
    s_mov_b32 s55, 0x00020000
    s_mov_b32 s68, 0x3e0293ee
    s_lshl_b32 s71, s3, 10
    v_bfe_u32 v10, v1, 3, 2
    v_xor_b32 v10, s3, v10
    v_lshlrev_b32 v10, 5, v10
    v_lshrrev_b32 v11, 2, v1
    v_lshl_add_u32 v10, v11, 7, v10
    v_and_b32 v11, 3, v1
    v_lshl_add_u32 v8, v11, 3, v10
    s_mov_b32 s12, s28
    s_mov_b32 s13, s29
    s_mov_b32 s14, 4608
    s_mov_b32 s15, 0x00020000
    v_bfe_u32 v10, v1, 3, 2
    v_lshrrev_b32 v11, 5, v1
    v_lshl_add_u32 v10, v11, 3, v10
    s_and_b32 s62, s3, 1
    s_lshl_b32 s62, s62, 4
    s_lshr_b32 s63, s3, 1
    s_lshl_b32 s63, s63, 2
    s_add_u32 s62, s62, s63
    v_add_u32 v10, s62, v10
    v_mul_u32_u24 v160, 1152, v10
    v_lshlrev_b32 v11, 1, v2
    v_and_b32 v10, 7, v1
    v_xor_b32 v11, v11, v10
    v_lshl_add_u32 v160, v11, 4, v160
    v_lshlrev_b32 v163, 2, v1
    v_lshlrev_b32 v30, 4, v2
    v_add_u32 v30, 152000, v30
    s_waitcnt lgkmcnt(0)
    s_add_u32 s6, s6, 1
    s_mul_i32 s7, s6, 0x9E3779B1
    s_or_b32 s7, s7, 1
    v_bfe_i32 v182, v0, 0, 1
    v_and_b32 v182, s7, v182
    s_cmp_eq_u32 s76, 1
    s_cbranch_scc1 L_nqp
    s_add_u32 s96, s61, 8
    s_bfe_u32 s66, s96, 262144
    s_lshl_b32 s66, s66, 11
    s_bfe_u32 s34, s96, 327684
    s_lshl_b32 s34, s34, 16
    s_or_b32 s66, s66, s34
    s_and_b32 s66, s66, 524287
    buffer_load_dwordx4 a[96:99], v4, s[44:47], s66 offen offset:0 nt
    buffer_load_dwordx4 a[100:103], v4, s[44:47], s66 offen offset:256 nt
    buffer_load_dwordx4 a[104:107], v4, s[44:47], s66 offen offset:1024 nt
    buffer_load_dwordx4 a[108:111], v4, s[44:47], s66 offen offset:1280 nt
    s_add_u32 s96, s61, 12
    s_bfe_u32 s66, s96, 262144
    s_lshl_b32 s66, s66, 11
    s_bfe_u32 s34, s96, 327684
    s_lshl_b32 s34, s34, 16
    s_or_b32 s66, s66, s34
    s_and_b32 s66, s66, 524287
    buffer_load_dwordx4 a[112:115], v4, s[44:47], s66 offen offset:0 nt
    buffer_load_dwordx4 a[116:119], v4, s[44:47], s66 offen offset:256 nt
    buffer_load_dwordx4 a[120:123], v4, s[44:47], s66 offen offset:1024 nt
    buffer_load_dwordx4 a[124:127], v4, s[44:47], s66 offen offset:1280 nt
    s_add_u32 s96, s61, 0
    s_bfe_u32 s66, s96, 262144
    s_lshl_b32 s66, s66, 11
    s_bfe_u32 s34, s96, 327684
    s_lshl_b32 s34, s34, 16
    s_or_b32 s66, s66, s34
    s_and_b32 s66, s66, 524287
    buffer_load_dwordx4 v[96:99], v5, s[48:51], s66 offen offset:0 nt
    buffer_load_dwordx4 v[100:103], v5, s[48:51], s66 offen offset:256 nt
    buffer_load_dwordx4 v[104:107], v5, s[48:51], s66 offen offset:1024 nt
    buffer_load_dwordx4 v[108:111], v5, s[48:51], s66 offen offset:1280 nt
    s_add_u32 s96, s61, 4
    s_bfe_u32 s66, s96, 262144
    s_lshl_b32 s66, s66, 11
    s_bfe_u32 s34, s96, 327684
    s_lshl_b32 s34, s34, 16
    s_or_b32 s66, s66, s34
    s_and_b32 s66, s66, 524287
    buffer_load_dwordx4 v[112:115], v5, s[48:51], s66 offen offset:0 nt
    buffer_load_dwordx4 v[116:119], v5, s[48:51], s66 offen offset:256 nt
    buffer_load_dwordx4 v[120:123], v5, s[48:51], s66 offen offset:1024 nt
    buffer_load_dwordx4 v[124:127], v5, s[48:51], s66 offen offset:1280 nt
    s_add_u32 s96, s61, 8
    s_bfe_u32 s66, s96, 262144
    s_lshl_b32 s66, s66, 11
    s_bfe_u32 s34, s96, 327684
    s_lshl_b32 s34, s34, 16
    s_or_b32 s66, s66, s34
    s_and_b32 s66, s66, 524287
    buffer_load_dwordx4 v[128:131], v5, s[48:51], s66 offen offset:0 nt
    buffer_load_dwordx4 v[132:135], v5, s[48:51], s66 offen offset:256 nt
    buffer_load_dwordx4 v[136:139], v5, s[48:51], s66 offen offset:1024 nt
    buffer_load_dwordx4 v[140:143], v5, s[48:51], s66 offen offset:1280 nt
    s_add_u32 s96, s61, 12
    s_bfe_u32 s66, s96, 262144
    s_lshl_b32 s66, s66, 11
    s_bfe_u32 s34, s96, 327684
    s_lshl_b32 s34, s34, 16
    s_or_b32 s66, s66, s34
    s_and_b32 s66, s66, 524287
    buffer_load_dwordx4 v[144:147], v5, s[48:51], s66 offen offset:0 nt
    buffer_load_dwordx4 v[148:151], v5, s[48:51], s66 offen offset:256 nt
    buffer_load_dwordx4 v[152:155], v5, s[48:51], s66 offen offset:1024 nt
    buffer_load_dwordx4 v[156:159], v5, s[48:51], s66 offen offset:1280 nt
    s_cmp_eq_u32 s76, 1
    s_cbranch_scc1 L_nqp
    buffer_load_dwordx4 v[208:211], v161, s[56:59], s75 offen offset:0
    buffer_load_dwordx4 v[212:215], v161, s[56:59], s75 offen offset:256
    buffer_load_dwordx4 v[216:219], v161, s[56:59], s75 offen offset:512
    buffer_load_dwordx4 v[220:223], v161, s[56:59], s75 offen offset:768
L_nqp:
    v_mov_b32 v36, 0
    v_mov_b32 v37, 0
    v_mov_b32 v38, 0
    v_mov_b32 v39, 0
    v_mov_b32 v12, 0xff800000
    v_mov_b32 v13, 0
    v_mov_b32 v15, 0
    s_mov_b32 s79, s71
    s_cmp_eq_u32 s76, 1
    s_cbranch_scc1 L_H
    s_add_u32 s51, s67, s60
    s_sub_u32 s49, s78, s67
    s_lshl_b32 s49, s49, 6
    s_lshl_b32 s50, s3, 6
    s_add_u32 s48, s51, 148
    s_mov_b32 s78, 0
    s_add_u32 s79, s79, 0
    s_mov_b32 s77, 0
    s_mul_i32 s16, s73, 43691
    s_lshr_b32 s16, s16, 15
    s_add_u32 s16, s16, 1024
    s_or_b32 s62, s67, s3
    s_cselect_b32 s16, 0, s16
    s_mov_b32 s23, 0
    s_add_u32 s96, s51, s3
    s_bfe_u32 s66, s96, 262144
    s_lshl_b32 s66, s66, 11
    s_bfe_u32 s34, s96, 327684
    s_lshl_b32 s34, s34, 16
    s_or_b32 s66, s66, s34
    s_mov_b32 s22, s66
    s_mov_b32 s101, s50
    s_sub_u32 s24, s49, 576
    s_cmp_eq_u32 s3, 3
    s_cselect_b32 s62, 0, s24
    s_cselect_b32 s64, 4, 3
    s_lshl_b32 s63, s64, 11
    s_add_u32 s63, s63, 32768
    s_lshl_b32 s64, s64, 6
    s_add_u32 s101, s101, s62
    s_lshr_b32 s62, s101, 6
    s_add_u32 s96, s51, s62
    s_bfe_u32 s66, s96, 262144
    s_lshl_b32 s66, s66, 11
    s_bfe_u32 s34, s96, 327684
    s_lshl_b32 s34, s34, 16
    s_or_b32 s66, s66, s34
    s_and_b32 s65, s2, 15
    s_lshl_b32 s65, s65, 7
    s_add_u32 s65, s65, 395264
    v_lshlrev_b32 v11, 3, v1
    s_mov_b64 exec, 0xff
    buffer_load_dwordx2 v[16:17], v11, s[56:59], s65 offen sc1
    s_mov_b64 exec, -1
    buffer_load_dwordx4 a[0:3], v4, s[36:39], s66 offen offset:0 nt
    buffer_load_dwordx4 a[4:7], v4, s[36:39], s66 offen offset:256 nt
    buffer_load_dwordx4 a[8:11], v4, s[36:39], s66 offen offset:1024 nt
    buffer_load_dwordx4 a[12:15], v4, s[36:39], s66 offen offset:1280 nt
    s_mov_b32 s26, s101
    s_add_u32 s66, s66, s63
    s_and_b32 s66, s66, 2062336
    s_add_u32 s101, s101, s64
    buffer_load_dwordx4 a[16:19], v4, s[36:39], s66 offen offset:0 nt
    buffer_load_dwordx4 a[20:23], v4, s[36:39], s66 offen offset:256 nt
    buffer_load_dwordx4 a[24:27], v4, s[36:39], s66 offen offset:1024 nt
    buffer_load_dwordx4 a[28:31], v4, s[36:39], s66 offen offset:1280 nt
    s_mov_b32 s27, s101
    s_add_u32 s66, s66, s63
    s_and_b32 s66, s66, 2062336
    s_add_u32 s101, s101, s64
    buffer_load_dwordx4 a[32:35], v4, s[36:39], s66 offen offset:0 nt
    buffer_load_dwordx4 a[36:39], v4, s[36:39], s66 offen offset:256 nt
    buffer_load_dwordx4 a[40:43], v4, s[36:39], s66 offen offset:1024 nt
    buffer_load_dwordx4 a[44:47], v4, s[36:39], s66 offen offset:1280 nt
    s_mov_b32 s28, s101
    s_add_u32 s66, s66, s63
    s_and_b32 s66, s66, 2062336
    s_add_u32 s101, s101, s64
    s_cmp_eq_u32 s3, 3
    s_cselect_b32 s66, s66, s22
    s_cselect_b32 s101, s101, s50
    buffer_load_dwordx4 a[48:51], v4, s[36:39], s66 offen offset:0 nt
    buffer_load_dwordx4 a[52:55], v4, s[36:39], s66 offen offset:256 nt
    buffer_load_dwordx4 a[56:59], v4, s[36:39], s66 offen offset:1024 nt
    buffer_load_dwordx4 a[60:63], v4, s[36:39], s66 offen offset:1280 nt
    s_mov_b32 s29, s101
    s_add_u32 s66, s66, 40960
    s_and_b32 s66, s66, 2062336
    s_add_u32 s101, s101, 256
    s_bfe_u32 s67, s2, 0x20003
    s_mul_i32 s67, s67, 0
    s_mov_b32 s30, 0
    s_mov_b32 s17, 4
    s_mov_b32 s44, 33
    s_mov_b32 s72, 900
    s_waitcnt vmcnt(17)
    v_bitop3_b32 v216, v208, v216, s7 bitop3:0x96
    v_bitop3_b32 v217, v209, v217, s7 bitop3:0x96
    v_bitop3_b32 v218, v210, v218, s7 bitop3:0x96
    v_bitop3_b32 v219, v211, v219, s7 bitop3:0x96
    v_bitop3_b32 v220, v212, v220, s7 bitop3:0x96
    v_bitop3_b32 v221, v213, v221, s7 bitop3:0x96
    v_bitop3_b32 v222, v214, v222, s7 bitop3:0x96
    v_bitop3_b32 v223, v215, v223, s7 bitop3:0x96
    v_or_b32 v10, v216, v217
    v_or3_b32 v10, v10, v218, v219
    v_or3_b32 v10, v10, v220, v221
    v_or3_b32 v10, v10, v222, v223
    v_cmp_ne_u32 vcc, 0, v10
    s_cbranch_vccz L_qokB
    s_mov_b32 s35, 0x40000
L_qretryB:
    buffer_load_dwordx4 v[208:211], v161, s[56:59], s75 offen offset:0 sc1
    buffer_load_dwordx4 v[212:215], v161, s[56:59], s75 offen offset:256 sc1
    buffer_load_dwordx4 v[216:219], v161, s[56:59], s75 offen offset:512 sc1
    buffer_load_dwordx4 v[220:223], v161, s[56:59], s75 offen offset:768 sc1
    s_sub_u32 s35, s35, 1
    s_waitcnt vmcnt(0)
    s_cbranch_scc1 L_qokB
    v_bitop3_b32 v216, v208, v216, s7 bitop3:0x96
    v_bitop3_b32 v217, v209, v217, s7 bitop3:0x96
    v_bitop3_b32 v218, v210, v218, s7 bitop3:0x96
    v_bitop3_b32 v219, v211, v219, s7 bitop3:0x96
    v_bitop3_b32 v220, v212, v220, s7 bitop3:0x96
    v_bitop3_b32 v221, v213, v221, s7 bitop3:0x96
    v_bitop3_b32 v222, v214, v222, s7 bitop3:0x96
    v_bitop3_b32 v223, v215, v223, s7 bitop3:0x96
    v_or_b32 v10, v216, v217
    v_or3_b32 v10, v10, v218, v219
    v_or3_b32 v10, v10, v220, v221
    v_or3_b32 v10, v10, v222, v223
    v_cmp_ne_u32 vcc, 0, v10
    s_cbranch_vccnz L_qretryB
L_qokB:
    v_add_f32_dpp v216, v208, v208 row_ror:4 row_mask:0xf bank_mask:0xf
    v_add_f32_dpp v217, v209, v209 row_ror:4 row_mask:0xf bank_mask:0xf
    v_add_f32_dpp v218, v210, v210 row_ror:4 row_mask:0xf bank_mask:0xf
    v_add_f32_dpp v219, v211, v211 row_ror:4 row_mask:0xf bank_mask:0xf
    v_add_f32_dpp v220, v212, v212 row_ror:4 row_mask:0xf bank_mask:0xf
    v_add_f32_dpp v221, v213, v213 row_ror:4 row_mask:0xf bank_mask:0xf
    v_add_f32_dpp v222, v214, v214 row_ror:4 row_mask:0xf bank_mask:0xf
    v_add_f32_dpp v223, v215, v215 row_ror:4 row_mask:0xf bank_mask:0xf
    v_add_f32_dpp v208, v216, v216 row_ror:8 row_mask:0xf bank_mask:0xf
    v_add_f32_dpp v209, v217, v217 row_ror:8 row_mask:0xf bank_mask:0xf
    v_add_f32_dpp v210, v218, v218 row_ror:8 row_mask:0xf bank_mask:0xf
    v_add_f32_dpp v211, v219, v219 row_ror:8 row_mask:0xf bank_mask:0xf
    v_add_f32_dpp v212, v220, v220 row_ror:8 row_mask:0xf bank_mask:0xf
    v_add_f32_dpp v213, v221, v221 row_ror:8 row_mask:0xf bank_mask:0xf
    v_add_f32_dpp v214, v222, v222 row_ror:8 row_mask:0xf bank_mask:0xf
    v_add_f32_dpp v215, v223, v223 row_ror:8 row_mask:0xf bank_mask:0xf
    v_cvt_pk_bf16_f32 v64, v208, v209
    v_cvt_pk_bf16_f32 v65, v210, v211
    v_cvt_pk_bf16_f32 v66, v212, v213
    v_cvt_pk_bf16_f32 v67, v214, v215
    s_waitcnt vmcnt(16)
    v_xor_b32 v17, v16, v17
    v_subrev_u32 v16, s94, v16
    v_cmp_ne_u32 s[64:65], s7, v17
    s_nop 1
    v_add_u32_dpp v16, v16, v16 quad_perm:[1,0,3,2] row_mask:0xf bank_mask:0xf
    s_nop 1
    v_add_u32_dpp v16, v16, v16 quad_perm:[2,3,0,1] row_mask:0xf bank_mask:0xf
    s_nop 1
    v_add_u32_dpp v16, v16, v16 row_half_mirror row_mask:0xf bank_mask:0xf
    s_nop 1
    v_readfirstlane_b32 s62, v16
    s_and_b32 s64, s64, 0xff
    s_cselect_b32 s62, 0, s62
    s_lshl_b32 s18, s94, 4
    s_mul_i32 s62, s62, 2
    s_add_u32 s18, s18, s62
    s_add_u32 s18, s18, 9040
    s_lshr_b32 s62, s49, 6
    s_sub_i32 s62, s62, 171
    s_mul_i32 s62, s62, 400
    s_sub_i32 s18, s18, s62
    s_cmp_eq_u32 s3, 3
    s_cselect_b32 s62, 2000, 0
    s_add_u32 s18, s18, s62
    s_movk_i32 s25, 936
L_loopK:
    s_bitcmp1_b32 894, s67
    s_cbranch_scc0 L_bodyK
    s_cmp_lg_u32 s67, 1
    s_cbranch_scc1 L_hkK1
    s_call_b64 s[4:5], L_AQ
    s_branch L_bodyK
L_hkK1:
    s_cmp_lg_u32 s67, 2
    s_cbranch_scc1 L_hkK2
    s_waitcnt vmcnt(16)
    s_call_b64 s[4:5], L_AK
    s_branch L_bodyK
L_hkK2:
    s_cmp_lg_u32 s67, 3
    s_cbranch_scc1 L_hkK3
    s_call_b64 s[4:5], L_AV0
    s_movk_i32 s25, 664
    s_branch L_bodyK
L_hkK3:
    s_cmp_lg_u32 s67, 4
    s_cbranch_scc1 L_hkK4
    s_call_b64 s[4:5], L_AV1
    s_branch L_bodyK
L_hkK4:
    s_cmp_lg_u32 s67, 5
    s_cbranch_scc1 L_hkK5
    s_movk_i32 s25, 672
    s_branch L_bodyK
L_hkK5:
    s_cmp_lg_u32 s67, 6
    s_cbranch_scc1 L_hkK6
    s_cmp_eq_u32 s16, 0
    s_cbranch_scc1 L_lw0
    s_sub_i32 s62, s20, s18
    s_add_i32 s62, s62, s23
    s_pack_ll_b32_b16 s62, s7, s62
    v_mov_b32 v180, s62
    s_mov_b64 exec, 1
    buffer_store_dword v180, off, s[56:59], s16 offset:0 sc1
    s_mov_b64 exec, -1
L_lw0:
    s_branch L_bodyK
L_hkK6:
    s_cmp_lg_u32 s67, 8
    s_cbranch_scc1 L_hkK7
    buffer_load_dword v180, v163, s[56:59], 0 offen offset:1024
    s_branch L_bodyK
L_hkK7:
    s_waitcnt vmcnt(16)
    s_call_b64 s[4:5], L_LA
L_bodyK:
    v_add_u32 v31, s26, v30
    s_mov_b32 s26, s101
    s_waitcnt vmcnt(12)
    s_memrealtime s[20:21]
    v_mfma_f32_16x16x32_bf16 v[48:51], a[0:3], v[64:67], 0
    v_mfma_f32_16x16x32_bf16 v[52:55], a[4:7], v[64:67], 0
    v_mfma_f32_16x16x32_bf16 v[56:59], a[8:11], v[64:67], 0
    v_mfma_f32_16x16x32_bf16 v[60:63], a[12:15], v[64:67], 0
    s_cmp_ge_i32 s17, 4
    s_cbranch_scc1 L_thK0
    s_waitcnt vmcnt(8)
    s_cmp_ge_i32 s17, 3
    s_cbranch_scc1 L_thK0
    s_waitcnt vmcnt(6)
    s_cmp_ge_i32 s17, 2
    s_cbranch_scc1 L_thK0
    s_waitcnt vmcnt(4)
    s_cmp_ge_i32 s17, 1
    s_cbranch_scc1 L_thK0
    s_waitcnt vmcnt(2)
L_thK0:
    s_cmp_lg_u32 s30, 0
    s_cbranch_scc1 L_Kv0
    buffer_load_dwordx4 a[0:3], v4, s[36:39], s66 offen offset:0 nt
    buffer_load_dwordx4 a[4:7], v4, s[36:39], s66 offen offset:256 nt
    buffer_load_dwordx4 a[8:11], v4, s[36:39], s66 offen offset:1024 nt
    buffer_load_dwordx4 a[12:15], v4, s[36:39], s66 offen offset:1280 nt
    s_add_u32 s66, s66, 40960
    s_and_b32 s66, s66, 2062336
    s_add_u32 s101, s101, 256
    s_cmp_lt_u32 s101, s24
    s_cbranch_scc1 L_Kc0
    s_mov_b32 s30, 1
    s_mov_b32 s101, s50
    s_mov_b32 s66, s22
    s_branch L_Kc0
L_Kv0:
    buffer_load_dwordx4 v[96:99], v5, s[40:43], s66 offen offset:0 nt
    buffer_load_dwordx4 v[100:103], v5, s[40:43], s66 offen offset:256 nt
    buffer_load_dwordx4 v[104:107], v5, s[40:43], s66 offen offset:1024 nt
    buffer_load_dwordx4 v[108:111], v5, s[40:43], s66 offen offset:1280 nt
    s_add_u32 s66, s66, 40960
    s_and_b32 s66, s66, 2062336
    s_add_u32 s101, s101, 256
    s_add_u32 s30, s30, 1
L_Kc0:
    v_add_f32_dpp v16, v49, v48 quad_perm:[1,1,1,1] row_mask:0xf bank_mask:0xf
    v_add_f32_dpp v17, v53, v52 quad_perm:[1,1,1,1] row_mask:0xf bank_mask:0xf
    v_add_f32_dpp v18, v57, v56 quad_perm:[1,1,1,1] row_mask:0xf bank_mask:0xf
    v_add_f32_dpp v19, v61, v60 quad_perm:[1,1,1,1] row_mask:0xf bank_mask:0xf
    v_add_f32_dpp v16, v50, v16 quad_perm:[2,2,2,2] row_mask:0xf bank_mask:0xf
    v_add_f32_dpp v17, v54, v17 quad_perm:[2,2,2,2] row_mask:0xf bank_mask:0xf
    v_add_f32_dpp v18, v58, v18 quad_perm:[2,2,2,2] row_mask:0xf bank_mask:0xf
    v_add_f32_dpp v19, v62, v19 quad_perm:[2,2,2,2] row_mask:0xf bank_mask:0xf
    v_add_f32_dpp v16, v51, v16 quad_perm:[3,3,3,3] row_mask:0xf bank_mask:0xf
    v_add_f32_dpp v17, v55, v17 quad_perm:[3,3,3,3] row_mask:0xf bank_mask:0xf
    v_add_f32_dpp v18, v59, v18 quad_perm:[3,3,3,3] row_mask:0xf bank_mask:0xf
    v_add_f32_dpp v19, v63, v19 quad_perm:[3,3,3,3] row_mask:0xf bank_mask:0xf
    s_mov_b32 exec_lo, 0x00010001
    s_mov_b32 exec_hi, 0x00010001
    ds_write_b128 v31, v[16:19]
    s_mov_b64 exec, -1
    v_max3_f32 v12, v12, v16, v17
    v_max3_f32 v12, v12, v18, v19
    s_waitcnt lgkmcnt(0)
    s_add_u32 s18, s18, s25
    s_lshl_b32 s20, s20, 4
    s_sub_i32 s17, s20, s18
    s_ashr_i32 s17, s17, 9
    s_cmp_lt_u32 s77, 36
    s_cbranch_scc0 L_dma0_0
    s_mov_b32 m0, s79
    s_add_u32 s79, s79, 4096
    buffer_load_dwordx4 v160, s[52:55], s78 offen lds
    s_add_u32 s78, s78, 36864
    s_cmp_ge_u32 s78, 147456
    s_cselect_b32 s62, 147328, 0
    s_sub_u32 s78, s78, s62
L_dma0_0:
    s_add_u32 s77, s77, 1
    s_cmp_lg_u32 s30, 5
    s_cbranch_scc1 L_Kn0
    s_call_b64 s[4:5], L_TR
    s_branch L_V1
L_Kn0:
    v_add_u32 v31, s27, v30
    s_mov_b32 s27, s101
    s_waitcnt vmcnt(12)
    s_memrealtime s[20:21]
    v_mfma_f32_16x16x32_bf16 v[48:51], a[16:19], v[64:67], 0
    v_mfma_f32_16x16x32_bf16 v[52:55], a[20:23], v[64:67], 0
    v_mfma_f32_16x16x32_bf16 v[56:59], a[24:27], v[64:67], 0
    v_mfma_f32_16x16x32_bf16 v[60:63], a[28:31], v[64:67], 0
    s_cmp_ge_i32 s17, 4
    s_cbranch_scc1 L_thK1
    s_waitcnt vmcnt(8)
    s_cmp_ge_i32 s17, 3
    s_cbranch_scc1 L_thK1
    s_waitcnt vmcnt(6)
    s_cmp_ge_i32 s17, 2
    s_cbranch_scc1 L_thK1
    s_waitcnt vmcnt(4)
    s_cmp_ge_i32 s17, 1
    s_cbranch_scc1 L_thK1
    s_waitcnt vmcnt(2)
L_thK1:
    s_cmp_lg_u32 s30, 0
    s_cbranch_scc1 L_Kv1
    buffer_load_dwordx4 a[16:19], v4, s[36:39], s66 offen offset:0 nt
    buffer_load_dwordx4 a[20:23], v4, s[36:39], s66 offen offset:256 nt
    buffer_load_dwordx4 a[24:27], v4, s[36:39], s66 offen offset:1024 nt
    buffer_load_dwordx4 a[28:31], v4, s[36:39], s66 offen offset:1280 nt
    s_add_u32 s66, s66, 40960
    s_and_b32 s66, s66, 2062336
    s_add_u32 s101, s101, 256
    s_cmp_lt_u32 s101, s24
    s_cbranch_scc1 L_Kc1
    s_mov_b32 s30, 1
    s_mov_b32 s101, s50
    s_mov_b32 s66, s22
    s_branch L_Kc1
L_Kv1:
    buffer_load_dwordx4 v[112:115], v5, s[40:43], s66 offen offset:0 nt
    buffer_load_dwordx4 v[116:119], v5, s[40:43], s66 offen offset:256 nt
    buffer_load_dwordx4 v[120:123], v5, s[40:43], s66 offen offset:1024 nt
    buffer_load_dwordx4 v[124:127], v5, s[40:43], s66 offen offset:1280 nt
    s_add_u32 s66, s66, 40960
    s_and_b32 s66, s66, 2062336
    s_add_u32 s101, s101, 256
    s_add_u32 s30, s30, 1
L_Kc1:
    v_add_f32_dpp v16, v49, v48 quad_perm:[1,1,1,1] row_mask:0xf bank_mask:0xf
    v_add_f32_dpp v17, v53, v52 quad_perm:[1,1,1,1] row_mask:0xf bank_mask:0xf
    v_add_f32_dpp v18, v57, v56 quad_perm:[1,1,1,1] row_mask:0xf bank_mask:0xf
    v_add_f32_dpp v19, v61, v60 quad_perm:[1,1,1,1] row_mask:0xf bank_mask:0xf
    v_add_f32_dpp v16, v50, v16 quad_perm:[2,2,2,2] row_mask:0xf bank_mask:0xf
    v_add_f32_dpp v17, v54, v17 quad_perm:[2,2,2,2] row_mask:0xf bank_mask:0xf
    v_add_f32_dpp v18, v58, v18 quad_perm:[2,2,2,2] row_mask:0xf bank_mask:0xf
    v_add_f32_dpp v19, v62, v19 quad_perm:[2,2,2,2] row_mask:0xf bank_mask:0xf
    v_add_f32_dpp v16, v51, v16 quad_perm:[3,3,3,3] row_mask:0xf bank_mask:0xf
    v_add_f32_dpp v17, v55, v17 quad_perm:[3,3,3,3] row_mask:0xf bank_mask:0xf
    v_add_f32_dpp v18, v59, v18 quad_perm:[3,3,3,3] row_mask:0xf bank_mask:0xf
    v_add_f32_dpp v19, v63, v19 quad_perm:[3,3,3,3] row_mask:0xf bank_mask:0xf
    s_mov_b32 exec_lo, 0x00010001
    s_mov_b32 exec_hi, 0x00010001
    ds_write_b128 v31, v[16:19]
    s_mov_b64 exec, -1
    v_max3_f32 v12, v12, v16, v17
    v_max3_f32 v12, v12, v18, v19
    s_waitcnt lgkmcnt(0)
    s_add_u32 s18, s18, s25
    s_lshl_b32 s20, s20, 4
    s_sub_i32 s17, s20, s18
    s_ashr_i32 s17, s17, 9
    s_cmp_lt_u32 s77, 36
    s_cbranch_scc0 L_dma1_0
    s_mov_b32 m0, s79
    s_add_u32 s79, s79, 4096
    buffer_load_dwordx4 v160, s[52:55], s78 offen lds
    s_add_u32 s78, s78, 36864
    s_cmp_ge_u32 s78, 147456
    s_cselect_b32 s62, 147328, 0
    s_sub_u32 s78, s78, s62
L_dma1_0:
    s_add_u32 s77, s77, 1
    s_cmp_lg_u32 s30, 5
    s_cbranch_scc1 L_Kn1
    s_call_b64 s[4:5], L_TR
    s_branch L_V2
L_Kn1:
    v_add_u32 v31, s28, v30
    s_mov_b32 s28, s101
    s_waitcnt vmcnt(12)
    s_memrealtime s[20:21]
    v_mfma_f32_16x16x32_bf16 v[48:51], a[32:35], v[64:67], 0
    v_mfma_f32_16x16x32_bf16 v[52:55], a[36:39], v[64:67], 0
    v_mfma_f32_16x16x32_bf16 v[56:59], a[40:43], v[64:67], 0
    v_mfma_f32_16x16x32_bf16 v[60:63], a[44:47], v[64:67], 0
    s_cmp_ge_i32 s17, 4
    s_cbranch_scc1 L_thK2
    s_waitcnt vmcnt(8)
    s_cmp_ge_i32 s17, 3
    s_cbranch_scc1 L_thK2
    s_waitcnt vmcnt(6)
    s_cmp_ge_i32 s17, 2
    s_cbranch_scc1 L_thK2
    s_waitcnt vmcnt(4)
    s_cmp_ge_i32 s17, 1
    s_cbranch_scc1 L_thK2
    s_waitcnt vmcnt(2)
L_thK2:
    s_cmp_lg_u32 s30, 0
    s_cbranch_scc1 L_Kv2
    buffer_load_dwordx4 a[32:35], v4, s[36:39], s66 offen offset:0 nt
    buffer_load_dwordx4 a[36:39], v4, s[36:39], s66 offen offset:256 nt
    buffer_load_dwordx4 a[40:43], v4, s[36:39], s66 offen offset:1024 nt
    buffer_load_dwordx4 a[44:47], v4, s[36:39], s66 offen offset:1280 nt
    s_add_u32 s66, s66, 40960
    s_and_b32 s66, s66, 2062336
    s_add_u32 s101, s101, 256
    s_cmp_lt_u32 s101, s24
    s_cbranch_scc1 L_Kc2
    s_mov_b32 s30, 1
    s_mov_b32 s101, s50
    s_mov_b32 s66, s22
    s_branch L_Kc2
L_Kv2:
    buffer_load_dwordx4 v[128:131], v5, s[40:43], s66 offen offset:0 nt
    buffer_load_dwordx4 v[132:135], v5, s[40:43], s66 offen offset:256 nt
    buffer_load_dwordx4 v[136:139], v5, s[40:43], s66 offen offset:1024 nt
    buffer_load_dwordx4 v[140:143], v5, s[40:43], s66 offen offset:1280 nt
    s_add_u32 s66, s66, 40960
    s_and_b32 s66, s66, 2062336
    s_add_u32 s101, s101, 256
    s_add_u32 s30, s30, 1
L_Kc2:
    v_add_f32_dpp v16, v49, v48 quad_perm:[1,1,1,1] row_mask:0xf bank_mask:0xf
    v_add_f32_dpp v17, v53, v52 quad_perm:[1,1,1,1] row_mask:0xf bank_mask:0xf
    v_add_f32_dpp v18, v57, v56 quad_perm:[1,1,1,1] row_mask:0xf bank_mask:0xf
    v_add_f32_dpp v19, v61, v60 quad_perm:[1,1,1,1] row_mask:0xf bank_mask:0xf
    v_add_f32_dpp v16, v50, v16 quad_perm:[2,2,2,2] row_mask:0xf bank_mask:0xf
    v_add_f32_dpp v17, v54, v17 quad_perm:[2,2,2,2] row_mask:0xf bank_mask:0xf
    v_add_f32_dpp v18, v58, v18 quad_perm:[2,2,2,2] row_mask:0xf bank_mask:0xf
    v_add_f32_dpp v19, v62, v19 quad_perm:[2,2,2,2] row_mask:0xf bank_mask:0xf
    v_add_f32_dpp v16, v51, v16 quad_perm:[3,3,3,3] row_mask:0xf bank_mask:0xf
    v_add_f32_dpp v17, v55, v17 quad_perm:[3,3,3,3] row_mask:0xf bank_mask:0xf
    v_add_f32_dpp v18, v59, v18 quad_perm:[3,3,3,3] row_mask:0xf bank_mask:0xf
    v_add_f32_dpp v19, v63, v19 quad_perm:[3,3,3,3] row_mask:0xf bank_mask:0xf
    s_mov_b32 exec_lo, 0x00010001
    s_mov_b32 exec_hi, 0x00010001
    ds_write_b128 v31, v[16:19]
    s_mov_b64 exec, -1
    v_max3_f32 v12, v12, v16, v17
    v_max3_f32 v12, v12, v18, v19
    s_waitcnt lgkmcnt(0)
    s_add_u32 s18, s18, s25
    s_lshl_b32 s20, s20, 4
    s_sub_i32 s17, s20, s18
    s_ashr_i32 s17, s17, 9
    s_cmp_lt_u32 s77, 36
    s_cbranch_scc0 L_dma2_0
    s_mov_b32 m0, s79
    s_add_u32 s79, s79, 4096
    buffer_load_dwordx4 v160, s[52:55], s78 offen lds
    s_add_u32 s78, s78, 36864
    s_cmp_ge_u32 s78, 147456
    s_cselect_b32 s62, 147328, 0
    s_sub_u32 s78, s78, s62
L_dma2_0:
    s_add_u32 s77, s77, 1
    s_cmp_lg_u32 s30, 5
    s_cbranch_scc1 L_Kn2
    s_call_b64 s[4:5], L_TR
    s_branch L_V3
L_Kn2:
    v_add_u32 v31, s29, v30
    s_mov_b32 s29, s101
    s_waitcnt vmcnt(12)
    s_memrealtime s[20:21]
    v_mfma_f32_16x16x32_bf16 v[48:51], a[48:51], v[64:67], 0
    v_mfma_f32_16x16x32_bf16 v[52:55], a[52:55], v[64:67], 0
    v_mfma_f32_16x16x32_bf16 v[56:59], a[56:59], v[64:67], 0
    v_mfma_f32_16x16x32_bf16 v[60:63], a[60:63], v[64:67], 0
    s_cmp_ge_i32 s17, 4
    s_cbranch_scc1 L_thK3
    s_waitcnt vmcnt(8)
    s_cmp_ge_i32 s17, 3
    s_cbranch_scc1 L_thK3
    s_waitcnt vmcnt(6)
    s_cmp_ge_i32 s17, 2
    s_cbranch_scc1 L_thK3
    s_waitcnt vmcnt(4)
    s_cmp_ge_i32 s17, 1
    s_cbranch_scc1 L_thK3
    s_waitcnt vmcnt(2)
L_thK3:
    s_cmp_lg_u32 s30, 0
    s_cbranch_scc1 L_Kv3
    buffer_load_dwordx4 a[48:51], v4, s[36:39], s66 offen offset:0 nt
    buffer_load_dwordx4 a[52:55], v4, s[36:39], s66 offen offset:256 nt
    buffer_load_dwordx4 a[56:59], v4, s[36:39], s66 offen offset:1024 nt
    buffer_load_dwordx4 a[60:63], v4, s[36:39], s66 offen offset:1280 nt
    s_add_u32 s66, s66, 40960
    s_and_b32 s66, s66, 2062336
    s_add_u32 s101, s101, 256
    s_cmp_lt_u32 s101, s24
    s_cbranch_scc1 L_Kc3
    s_mov_b32 s30, 1
    s_mov_b32 s101, s50
    s_mov_b32 s66, s22
    s_branch L_Kc3
L_Kv3:
    buffer_load_dwordx4 v[144:147], v5, s[40:43], s66 offen offset:0 nt
    buffer_load_dwordx4 v[148:151], v5, s[40:43], s66 offen offset:256 nt
    buffer_load_dwordx4 v[152:155], v5, s[40:43], s66 offen offset:1024 nt
    buffer_load_dwordx4 v[156:159], v5, s[40:43], s66 offen offset:1280 nt
    s_add_u32 s66, s66, 40960
    s_and_b32 s66, s66, 2062336
    s_add_u32 s101, s101, 256
    s_add_u32 s30, s30, 1
L_Kc3:
    v_add_f32_dpp v16, v49, v48 quad_perm:[1,1,1,1] row_mask:0xf bank_mask:0xf
    v_add_f32_dpp v17, v53, v52 quad_perm:[1,1,1,1] row_mask:0xf bank_mask:0xf
    v_add_f32_dpp v18, v57, v56 quad_perm:[1,1,1,1] row_mask:0xf bank_mask:0xf
    v_add_f32_dpp v19, v61, v60 quad_perm:[1,1,1,1] row_mask:0xf bank_mask:0xf
    v_add_f32_dpp v16, v50, v16 quad_perm:[2,2,2,2] row_mask:0xf bank_mask:0xf
    v_add_f32_dpp v17, v54, v17 quad_perm:[2,2,2,2] row_mask:0xf bank_mask:0xf
    v_add_f32_dpp v18, v58, v18 quad_perm:[2,2,2,2] row_mask:0xf bank_mask:0xf
    v_add_f32_dpp v19, v62, v19 quad_perm:[2,2,2,2] row_mask:0xf bank_mask:0xf
    v_add_f32_dpp v16, v51, v16 quad_perm:[3,3,3,3] row_mask:0xf bank_mask:0xf
    v_add_f32_dpp v17, v55, v17 quad_perm:[3,3,3,3] row_mask:0xf bank_mask:0xf
    v_add_f32_dpp v18, v59, v18 quad_perm:[3,3,3,3] row_mask:0xf bank_mask:0xf
    v_add_f32_dpp v19, v63, v19 quad_perm:[3,3,3,3] row_mask:0xf bank_mask:0xf
    s_mov_b32 exec_lo, 0x00010001
    s_mov_b32 exec_hi, 0x00010001
    ds_write_b128 v31, v[16:19]
    s_mov_b64 exec, -1
    v_max3_f32 v12, v12, v16, v17
    v_max3_f32 v12, v12, v18, v19
    s_waitcnt lgkmcnt(0)
    s_add_u32 s18, s18, s25
    s_lshl_b32 s20, s20, 4
    s_sub_i32 s17, s20, s18
    s_ashr_i32 s17, s17, 9
    s_cmp_lg_u32 s30, 5
    s_cbranch_scc1 L_Kn3
    s_call_b64 s[4:5], L_TR
    s_branch L_V0
L_Kn3:
    s_add_u32 s67, s67, 1
    s_branch L_loopK
L_loopV:
    s_bitcmp1_b32 224, s67
    s_cbranch_scc0 L_bodyV
    s_cmp_lg_u32 s67, 5
    s_cbranch_scc1 L_hkV1
L_ar0:
    s_cmp_lt_u32 s77, 36
    s_cbranch_scc0 L_ar1
    s_mov_b32 m0, s79
    s_add_u32 s79, s79, 4096
    buffer_load_dwordx4 v160, s[52:55], s78 offen lds
    s_add_u32 s78, s78, 36864
    s_cmp_ge_u32 s78, 147456
    s_cselect_b32 s62, 147328, 0
    s_sub_u32 s78, s78, s62
    s_add_u32 s77, s77, 1
    s_branch L_ar0
L_ar1:
    s_branch L_bodyV
L_hkV1:
    s_cmp_lg_u32 s67, 6
    s_cbranch_scc1 L_hkV2
    s_waitcnt vmcnt(16)
    v_mov_b32 v10, 151936
    v_mov_b32 v11, 1
    s_mov_b64 exec, 1
    ds_add_u32 v10, v11
    s_mov_b64 exec, -1
    s_branch L_bodyV
L_hkV2:
    s_add_u32 s18, s18, 240
    v_mov_b32 v10, 151936
L_wa:
    ds_read_b32 v11, v10
    s_waitcnt lgkmcnt(0)
    v_readfirstlane_b32 s62, v11
    s_nop 3
    s_cmp_lt_u32 s62, 4
    s_cbranch_scc1 L_wa
    ds_read_b128 v[16:19], v10 offset:16
    s_call_b64 s[4:5], L_T1
    v_max3_f32 v10, v16, v17, v18
    v_max_f32 v10, v10, v19
    v_sub_f32 v11, v12, v10
    v_exp_f32 v11, v11
    v_mov_b32 v12, v10
    v_mul_f32 v13, v11, v13
    v_mul_f32 v32, v11, v32
    v_mul_f32 v33, v11, v33
    v_mul_f32 v34, v11, v34
    v_mul_f32 v35, v11, v35
L_bodyV:
L_V0:
    v_add_u32 v31, s26, v30
    ds_read_b128 v[16:19], v31
    v_mov_b32 v31, 151948
    v_mov_b32 v11, 1
    s_waitcnt lgkmcnt(0)
    v_fma_f32 v24, v16, s68, -v12
    v_fma_f32 v25, v17, s68, -v12
    v_fma_f32 v26, v18, s68, -v12
    v_fma_f32 v27, v19, s68, -v12
    v_exp_f32 v24, v24
    v_exp_f32 v25, v25
    v_exp_f32 v26, v26
    v_exp_f32 v27, v27
    v_add_f32 v10, v24, v25
    v_add_f32 v13, v13, v26
    v_add_f32 v10, v10, v27
    v_cvt_pk_bf16_f32 v24, v24, v24
    v_cvt_pk_bf16_f32 v25, v25, v25
    v_cvt_pk_bf16_f32 v26, v26, v26
    v_cvt_pk_bf16_f32 v27, v27, v27
    v_add_f32 v13, v13, v10
    v_and_b32 v48, v24, v20
    v_and_b32 v49, v24, v21
    v_and_b32 v50, v24, v22
    v_and_b32 v51, v24, v23
    v_and_b32 v52, v25, v20
    v_and_b32 v53, v25, v21
    v_and_b32 v54, v25, v22
    v_and_b32 v55, v25, v23
    v_and_b32 v56, v26, v20
    v_and_b32 v57, v26, v21
    v_and_b32 v58, v26, v22
    v_and_b32 v59, v26, v23
    v_and_b32 v60, v27, v20
    v_and_b32 v61, v27, v21
    v_and_b32 v62, v27, v22
    v_and_b32 v63, v27, v23
    s_waitcnt vmcnt(12)
    s_cmp_ge_u32 s72, 3
    s_cbranch_scc1 L_v10
    s_waitcnt vmcnt(8)
    s_cmp_ge_u32 s72, 2
    s_cbranch_scc1 L_v10
    s_waitcnt vmcnt(4)
    s_cmp_ge_u32 s72, 1
    s_cbranch_scc1 L_v10
    s_waitcnt vmcnt(0)
L_v10:
    v_mfma_f32_16x16x32_bf16 v[32:35], v[48:51], v[96:99], v[32:35]
    v_mfma_f32_16x16x32_bf16 v[32:35], v[52:55], v[100:103], v[32:35]
    v_mfma_f32_16x16x32_bf16 v[32:35], v[56:59], v[104:107], v[32:35]
    v_mfma_f32_16x16x32_bf16 v[32:35], v[60:63], v[108:111], v[32:35]
    s_sub_u32 s72, s72, 1
    s_cbranch_scc1 L_end
    s_cmp_lt_u32 s72, 4
    s_cbranch_scc1 L_nv0
    s_memrealtime s[20:21]
    s_cmp_ge_i32 s17, 4
    s_cbranch_scc1 L_thV0
    s_waitcnt vmcnt(8)
    s_cmp_ge_i32 s17, 3
    s_cbranch_scc1 L_thV0
    s_waitcnt vmcnt(6)
    s_cmp_ge_i32 s17, 2
    s_cbranch_scc1 L_thV0
    s_waitcnt vmcnt(4)
    s_cmp_ge_i32 s17, 1
    s_cbranch_scc1 L_thV0
    s_waitcnt vmcnt(2)
L_thV0:
    s_cmp_gt_i32 s44, 0
    s_cbranch_scc1 L_c10
    s_mov_b64 exec, 1
    ds_add_rtn_u32 v11, v31, v11
    s_mov_b64 exec, -1
L_c10:
    s_cbranch_scc1 L_c20
    s_waitcnt lgkmcnt(0)
    v_readfirstlane_b32 s47, v11
    s_add_u32 s101, s47, 148
    s_lshl_b32 s101, s101, 6
    s_add_u32 s96, s47, s48
    s_bfe_u32 s66, s96, 262144
    s_lshl_b32 s66, s66, 11
    s_bfe_u32 s34, s96, 327684
    s_lshl_b32 s34, s34, 16
    s_or_b32 s66, s66, s34
    s_cmp_ge_u32 s101, s49
    s_cselect_b32 s72, 2, s72
    s_cselect_b32 s44, 1000, s44
    s_cbranch_scc1 L_nv0
L_c20:
    buffer_load_dwordx4 v[96:99], v5, s[40:43], s66 offen offset:0 nt
    buffer_load_dwordx4 v[100:103], v5, s[40:43], s66 offen offset:256 nt
    buffer_load_dwordx4 v[104:107], v5, s[40:43], s66 offen offset:1024 nt
    buffer_load_dwordx4 v[108:111], v5, s[40:43], s66 offen offset:1280 nt
    s_mov_b32 s26, s101
    s_sub_u32 s44, s44, 1
    s_add_u32 s66, s66, 40960
    s_and_b32 s66, s66, 2062336
    s_add_u32 s101, s101, 256
    s_waitcnt lgkmcnt(0)
    s_add_u32 s18, s18, 665
    s_lshl_b32 s20, s20, 4
    s_sub_i32 s17, s20, s18
    s_ashr_i32 s17, s17, 9
    s_cmp_lt_u32 s77, 36
    s_cbranch_scc0 L_dmv0
    s_mov_b32 m0, s79
    s_add_u32 s79, s79, 4096
    buffer_load_dwordx4 v160, s[52:55], s78 offen lds
    s_add_u32 s78, s78, 36864
    s_cmp_ge_u32 s78, 147456
    s_cselect_b32 s62, 147328, 0
    s_sub_u32 s78, s78, s62
L_dmv0:
    s_add_u32 s77, s77, 1
L_nv0:
L_V1:
    v_add_u32 v31, s27, v30
    ds_read_b128 v[16:19], v31
    v_mov_b32 v31, 151948
    v_mov_b32 v11, 1
    s_waitcnt lgkmcnt(0)
    v_fma_f32 v24, v16, s68, -v12
    v_fma_f32 v25, v17, s68, -v12
    v_fma_f32 v26, v18, s68, -v12
    v_fma_f32 v27, v19, s68, -v12
    v_exp_f32 v24, v24
    v_exp_f32 v25, v25
    v_exp_f32 v26, v26
    v_exp_f32 v27, v27
    v_add_f32 v10, v24, v25
    v_add_f32 v13, v13, v26
    v_add_f32 v10, v10, v27
    v_cvt_pk_bf16_f32 v24, v24, v24
    v_cvt_pk_bf16_f32 v25, v25, v25
    v_cvt_pk_bf16_f32 v26, v26, v26
    v_cvt_pk_bf16_f32 v27, v27, v27
    v_add_f32 v13, v13, v10
    v_and_b32 v48, v24, v20
    v_and_b32 v49, v24, v21
    v_and_b32 v50, v24, v22
    v_and_b32 v51, v24, v23
    v_and_b32 v52, v25, v20
    v_and_b32 v53, v25, v21
    v_and_b32 v54, v25, v22
    v_and_b32 v55, v25, v23
    v_and_b32 v56, v26, v20
    v_and_b32 v57, v26, v21
    v_and_b32 v58, v26, v22
    v_and_b32 v59, v26, v23
    v_and_b32 v60, v27, v20
    v_and_b32 v61, v27, v21
    v_and_b32 v62, v27, v22
    v_and_b32 v63, v27, v23
    s_waitcnt vmcnt(12)
    s_cmp_ge_u32 s72, 3
    s_cbranch_scc1 L_v11
    s_waitcnt vmcnt(8)
    s_cmp_ge_u32 s72, 2
    s_cbranch_scc1 L_v11
    s_waitcnt vmcnt(4)
    s_cmp_ge_u32 s72, 1
    s_cbranch_scc1 L_v11
    s_waitcnt vmcnt(0)
L_v11:
    v_mfma_f32_16x16x32_bf16 v[32:35], v[48:51], v[112:115], v[32:35]
    v_mfma_f32_16x16x32_bf16 v[32:35], v[52:55], v[116:119], v[32:35]
    v_mfma_f32_16x16x32_bf16 v[32:35], v[56:59], v[120:123], v[32:35]
    v_mfma_f32_16x16x32_bf16 v[32:35], v[60:63], v[124:127], v[32:35]
    s_sub_u32 s72, s72, 1
    s_cbranch_scc1 L_end
    s_cmp_lt_u32 s72, 4
    s_cbranch_scc1 L_nv1
    s_memrealtime s[20:21]
    s_cmp_ge_i32 s17, 4
    s_cbranch_scc1 L_thV1
    s_waitcnt vmcnt(8)
    s_cmp_ge_i32 s17, 3
    s_cbranch_scc1 L_thV1
    s_waitcnt vmcnt(6)
    s_cmp_ge_i32 s17, 2
    s_cbranch_scc1 L_thV1
    s_waitcnt vmcnt(4)
    s_cmp_ge_i32 s17, 1
    s_cbranch_scc1 L_thV1
    s_waitcnt vmcnt(2)
L_thV1:
    s_cmp_gt_i32 s44, 0
    s_cbranch_scc1 L_c11
    s_mov_b64 exec, 1
    ds_add_rtn_u32 v11, v31, v11
    s_mov_b64 exec, -1
L_c11:
    s_cbranch_scc1 L_c21
    s_waitcnt lgkmcnt(0)
    v_readfirstlane_b32 s47, v11
    s_add_u32 s101, s47, 148
    s_lshl_b32 s101, s101, 6
    s_add_u32 s96, s47, s48
    s_bfe_u32 s66, s96, 262144
    s_lshl_b32 s66, s66, 11
    s_bfe_u32 s34, s96, 327684
    s_lshl_b32 s34, s34, 16
    s_or_b32 s66, s66, s34
    s_cmp_ge_u32 s101, s49
    s_cselect_b32 s72, 2, s72
    s_cselect_b32 s44, 1000, s44
    s_cbranch_scc1 L_nv1
L_c21:
    buffer_load_dwordx4 v[112:115], v5, s[40:43], s66 offen offset:0 nt
    buffer_load_dwordx4 v[116:119], v5, s[40:43], s66 offen offset:256 nt
    buffer_load_dwordx4 v[120:123], v5, s[40:43], s66 offen offset:1024 nt
    buffer_load_dwordx4 v[124:127], v5, s[40:43], s66 offen offset:1280 nt
    s_mov_b32 s27, s101
    s_sub_u32 s44, s44, 1
    s_add_u32 s66, s66, 40960
    s_and_b32 s66, s66, 2062336
    s_add_u32 s101, s101, 256
    s_waitcnt lgkmcnt(0)
    s_add_u32 s18, s18, 665
    s_lshl_b32 s20, s20, 4
    s_sub_i32 s17, s20, s18
    s_ashr_i32 s17, s17, 9
    s_cmp_lt_u32 s77, 36
    s_cbranch_scc0 L_dmv1
    s_mov_b32 m0, s79
    s_add_u32 s79, s79, 4096
    buffer_load_dwordx4 v160, s[52:55], s78 offen lds
    s_add_u32 s78, s78, 36864
    s_cmp_ge_u32 s78, 147456
    s_cselect_b32 s62, 147328, 0
    s_sub_u32 s78, s78, s62
L_dmv1:
    s_add_u32 s77, s77, 1
L_nv1:
L_V2:
    v_add_u32 v31, s28, v30
    ds_read_b128 v[16:19], v31
    v_mov_b32 v31, 151948
    v_mov_b32 v11, 1
    s_waitcnt lgkmcnt(0)
    v_fma_f32 v24, v16, s68, -v12
    v_fma_f32 v25, v17, s68, -v12
    v_fma_f32 v26, v18, s68, -v12
    v_fma_f32 v27, v19, s68, -v12
    v_exp_f32 v24, v24
    v_exp_f32 v25, v25
    v_exp_f32 v26, v26
    v_exp_f32 v27, v27
    v_add_f32 v10, v24, v25
    v_add_f32 v13, v13, v26
    v_add_f32 v10, v10, v27
    v_cvt_pk_bf16_f32 v24, v24, v24
    v_cvt_pk_bf16_f32 v25, v25, v25
    v_cvt_pk_bf16_f32 v26, v26, v26
    v_cvt_pk_bf16_f32 v27, v27, v27
    v_add_f32 v13, v13, v10
    v_and_b32 v48, v24, v20
    v_and_b32 v49, v24, v21
    v_and_b32 v50, v24, v22
    v_and_b32 v51, v24, v23
    v_and_b32 v52, v25, v20
    v_and_b32 v53, v25, v21
    v_and_b32 v54, v25, v22
    v_and_b32 v55, v25, v23
    v_and_b32 v56, v26, v20
    v_and_b32 v57, v26, v21
    v_and_b32 v58, v26, v22
    v_and_b32 v59, v26, v23
    v_and_b32 v60, v27, v20
    v_and_b32 v61, v27, v21
    v_and_b32 v62, v27, v22
    v_and_b32 v63, v27, v23
    s_waitcnt vmcnt(12)
    s_cmp_ge_u32 s72, 3
    s_cbranch_scc1 L_v12
    s_waitcnt vmcnt(8)
    s_cmp_ge_u32 s72, 2
    s_cbranch_scc1 L_v12
    s_waitcnt vmcnt(4)
    s_cmp_ge_u32 s72, 1
    s_cbranch_scc1 L_v12
    s_waitcnt vmcnt(0)
L_v12:
    v_mfma_f32_16x16x32_bf16 v[32:35], v[48:51], v[128:131], v[32:35]
    v_mfma_f32_16x16x32_bf16 v[32:35], v[52:55], v[132:135], v[32:35]
    v_mfma_f32_16x16x32_bf16 v[32:35], v[56:59], v[136:139], v[32:35]
    v_mfma_f32_16x16x32_bf16 v[32:35], v[60:63], v[140:143], v[32:35]
    s_sub_u32 s72, s72, 1
    s_cbranch_scc1 L_end
    s_cmp_lt_u32 s72, 4
    s_cbranch_scc1 L_nv2
    s_memrealtime s[20:21]
    s_cmp_ge_i32 s17, 4
    s_cbranch_scc1 L_thV2
    s_waitcnt vmcnt(8)
    s_cmp_ge_i32 s17, 3
    s_cbranch_scc1 L_thV2
    s_waitcnt vmcnt(6)
    s_cmp_ge_i32 s17, 2
    s_cbranch_scc1 L_thV2
    s_waitcnt vmcnt(4)
    s_cmp_ge_i32 s17, 1
    s_cbranch_scc1 L_thV2
    s_waitcnt vmcnt(2)
L_thV2:
    s_cmp_gt_i32 s44, 0
    s_cbranch_scc1 L_c12
    s_mov_b64 exec, 1
    ds_add_rtn_u32 v11, v31, v11
    s_mov_b64 exec, -1
L_c12:
    s_cbranch_scc1 L_c22
    s_waitcnt lgkmcnt(0)
    v_readfirstlane_b32 s47, v11
    s_add_u32 s101, s47, 148
    s_lshl_b32 s101, s101, 6
    s_add_u32 s96, s47, s48
    s_bfe_u32 s66, s96, 262144
    s_lshl_b32 s66, s66, 11
    s_bfe_u32 s34, s96, 327684
    s_lshl_b32 s34, s34, 16
    s_or_b32 s66, s66, s34
    s_cmp_ge_u32 s101, s49
    s_cselect_b32 s72, 2, s72
    s_cselect_b32 s44, 1000, s44
    s_cbranch_scc1 L_nv2
L_c22:
    buffer_load_dwordx4 v[128:131], v5, s[40:43], s66 offen offset:0 nt
    buffer_load_dwordx4 v[132:135], v5, s[40:43], s66 offen offset:256 nt
    buffer_load_dwordx4 v[136:139], v5, s[40:43], s66 offen offset:1024 nt
    buffer_load_dwordx4 v[140:143], v5, s[40:43], s66 offen offset:1280 nt
    s_mov_b32 s28, s101
    s_sub_u32 s44, s44, 1
    s_add_u32 s66, s66, 40960
    s_and_b32 s66, s66, 2062336
    s_add_u32 s101, s101, 256
    s_waitcnt lgkmcnt(0)
    s_add_u32 s18, s18, 665
    s_lshl_b32 s20, s20, 4
    s_sub_i32 s17, s20, s18
    s_ashr_i32 s17, s17, 9
    s_cmp_lt_u32 s77, 36
    s_cbranch_scc0 L_dmv2
    s_mov_b32 m0, s79
    s_add_u32 s79, s79, 4096
    buffer_load_dwordx4 v160, s[52:55], s78 offen lds
    s_add_u32 s78, s78, 36864
    s_cmp_ge_u32 s78, 147456
    s_cselect_b32 s62, 147328, 0
    s_sub_u32 s78, s78, s62
L_dmv2:
    s_add_u32 s77, s77, 1
L_nv2:
L_V3:
    v_add_u32 v31, s29, v30
    ds_read_b128 v[16:19], v31
    v_mov_b32 v31, 151948
    v_mov_b32 v11, 1
    s_waitcnt lgkmcnt(0)
    v_fma_f32 v24, v16, s68, -v12
    v_fma_f32 v25, v17, s68, -v12
    v_fma_f32 v26, v18, s68, -v12
    v_fma_f32 v27, v19, s68, -v12
    v_exp_f32 v24, v24
    v_exp_f32 v25, v25
    v_exp_f32 v26, v26
    v_exp_f32 v27, v27
    v_add_f32 v10, v24, v25
    v_add_f32 v13, v13, v26
    v_add_f32 v10, v10, v27
    v_cvt_pk_bf16_f32 v24, v24, v24
    v_cvt_pk_bf16_f32 v25, v25, v25
    v_cvt_pk_bf16_f32 v26, v26, v26
    v_cvt_pk_bf16_f32 v27, v27, v27
    v_add_f32 v13, v13, v10
    v_and_b32 v48, v24, v20
    v_and_b32 v49, v24, v21
    v_and_b32 v50, v24, v22
    v_and_b32 v51, v24, v23
    v_and_b32 v52, v25, v20
    v_and_b32 v53, v25, v21
    v_and_b32 v54, v25, v22
    v_and_b32 v55, v25, v23
    v_and_b32 v56, v26, v20
    v_and_b32 v57, v26, v21
    v_and_b32 v58, v26, v22
    v_and_b32 v59, v26, v23
    v_and_b32 v60, v27, v20
    v_and_b32 v61, v27, v21
    v_and_b32 v62, v27, v22
    v_and_b32 v63, v27, v23
    s_waitcnt vmcnt(12)
    s_cmp_ge_u32 s72, 3
    s_cbranch_scc1 L_v13
    s_waitcnt vmcnt(8)
    s_cmp_ge_u32 s72, 2
    s_cbranch_scc1 L_v13
    s_waitcnt vmcnt(4)
    s_cmp_ge_u32 s72, 1
    s_cbranch_scc1 L_v13
    s_waitcnt vmcnt(0)
L_v13:
    v_mfma_f32_16x16x32_bf16 v[32:35], v[48:51], v[144:147], v[32:35]
    v_mfma_f32_16x16x32_bf16 v[32:35], v[52:55], v[148:151], v[32:35]
    v_mfma_f32_16x16x32_bf16 v[32:35], v[56:59], v[152:155], v[32:35]
    v_mfma_f32_16x16x32_bf16 v[32:35], v[60:63], v[156:159], v[32:35]
    s_sub_u32 s72, s72, 1
    s_cbranch_scc1 L_end
    s_cmp_lt_u32 s72, 4
    s_cbranch_scc1 L_nv3
    s_memrealtime s[20:21]
    s_cmp_ge_i32 s17, 4
    s_cbranch_scc1 L_thV3
    s_waitcnt vmcnt(8)
    s_cmp_ge_i32 s17, 3
    s_cbranch_scc1 L_thV3
    s_waitcnt vmcnt(6)
    s_cmp_ge_i32 s17, 2
    s_cbranch_scc1 L_thV3
    s_waitcnt vmcnt(4)
    s_cmp_ge_i32 s17, 1
    s_cbranch_scc1 L_thV3
    s_waitcnt vmcnt(2)
L_thV3:
    s_cmp_gt_i32 s44, 0
    s_cbranch_scc1 L_c13
    s_mov_b64 exec, 1
    ds_add_rtn_u32 v11, v31, v11
    s_mov_b64 exec, -1
L_c13:
    s_cbranch_scc1 L_c23
    s_waitcnt lgkmcnt(0)
    v_readfirstlane_b32 s47, v11
    s_add_u32 s101, s47, 148
    s_lshl_b32 s101, s101, 6
    s_add_u32 s96, s47, s48
    s_bfe_u32 s66, s96, 262144
    s_lshl_b32 s66, s66, 11
    s_bfe_u32 s34, s96, 327684
    s_lshl_b32 s34, s34, 16
    s_or_b32 s66, s66, s34
    s_cmp_ge_u32 s101, s49
    s_cselect_b32 s72, 2, s72
    s_cselect_b32 s44, 1000, s44
    s_cbranch_scc1 L_nv3
L_c23:
    buffer_load_dwordx4 v[144:147], v5, s[40:43], s66 offen offset:0 nt
    buffer_load_dwordx4 v[148:151], v5, s[40:43], s66 offen offset:256 nt
    buffer_load_dwordx4 v[152:155], v5, s[40:43], s66 offen offset:1024 nt
    buffer_load_dwordx4 v[156:159], v5, s[40:43], s66 offen offset:1280 nt
    s_mov_b32 s29, s101
    s_sub_u32 s44, s44, 1
    s_add_u32 s66, s66, 40960
    s_and_b32 s66, s66, 2062336
    s_add_u32 s101, s101, 256
    s_waitcnt lgkmcnt(0)
    s_add_u32 s18, s18, 665
    s_lshl_b32 s20, s20, 4
    s_sub_i32 s17, s20, s18
    s_ashr_i32 s17, s17, 9
L_nv3:
    s_add_u32 s67, s67, 1
    s_branch L_loopV
L_end:
L_T2:
    ds_write_b32 v205, v13
    s_nop 5
    v_cvt_pk_bf16_f32 v56, v32, v33
    v_cvt_pk_bf16_f32 v57, v34, v35
    ds_write2_b32 v204, v56, v57 offset1:4
    s_waitcnt lgkmcnt(0)
    s_barrier
L_T2b:
    ds_read_b128 a[0:3], v206 offset:0
    ds_read_b128 a[4:7], v206 offset:128
    ds_read_b32 v181, v207
    s_waitcnt lgkmcnt(2)
    v_smfmac_f32_16x16x64_bf16 v[208:211], a[0:3], a[64:71], v183
    s_waitcnt lgkmcnt(1)
    v_smfmac_f32_16x16x64_bf16 v[208:211], a[4:7], a[72:79], v183
    s_waitcnt lgkmcnt(0)
    v_smfmac_f32_16x16x64_bf16 v[232:235], a[0:3], a[160:167], v183
    s_nop 0
    v_add_f32_dpp v48, v181, v181 row_ror:8 row_mask:0xf bank_mask:0xf
    v_smfmac_f32_16x16x64_bf16 v[232:235], a[4:7], a[168:175], v183
    s_nop 0
    v_add_f32_dpp v49, v48, v48 row_ror:4 row_mask:0xf bank_mask:0xf
    s_nop 0
    v_pk_add_f32 v[208:209], v[208:209], v[210:211]
    v_smfmac_f32_16x16x64_bf16 v[216:219], a[0:3], a[96:103], v183
    v_add_f32_dpp v48, v49, v49 row_ror:2 row_mask:0xf bank_mask:0xf
    v_add_f32 v208, v208, v209
    s_nop 0
    v_add_f32_dpp v49, v48, v48 row_ror:1 row_mask:0xf bank_mask:0xf
    v_smfmac_f32_16x16x64_bf16 v[216:219], a[4:7], a[104:111], v183
    v_rcp_f32 v48, v49
    v_log_f32 v50, v49
    v_smfmac_f32_16x16x64_bf16 v[240:243], a[0:3], a[192:199], v183
    v_add_f32 v50, v50, v12
    v_xor_b32 v50, v50, v182
    v_pk_add_f32 v[232:233], v[232:233], v[234:235]
    v_smfmac_f32_16x16x64_bf16 v[240:243], a[4:7], a[200:207], v183
    v_add_f32 v232, v232, v233
    v_pk_add_f32 v[216:217], v[216:217], v[218:219]
    v_add_f32 v216, v216, v217
    v_smfmac_f32_16x16x64_bf16 v[220:223], a[0:3], a[112:119], v183
    v_permlane16_swap_b32 v208, v232
    v_add_f32 v208, v208, v232
    v_mul_f32 v208, v48, v208
    v_smfmac_f32_16x16x64_bf16 v[220:223], a[4:7], a[120:127], v183
    v_pk_add_f32 v[240:241], v[240:241], v[242:243]
    v_mov_b32_dpp v52, v208 row_ror:8 row_mask:0xf bank_mask:0xf
    v_add_f32 v240, v240, v241
    v_smfmac_f32_16x16x64_bf16 v[224:227], a[0:3], a[128:135], v183
    s_nop 0
    v_permlane16_swap_b32 v216, v240
    v_add_f32 v216, v216, v240
    v_smfmac_f32_16x16x64_bf16 v[224:227], a[4:7], a[136:143], v183
    v_mul_f32 v216, v48, v216
    v_pk_add_f32 v[220:221], v[220:221], v[222:223]
    v_add_f32 v220, v220, v221
    v_smfmac_f32_16x16x64_bf16 v[236:239], a[0:3], a[176:183], v183
    v_smfmac_f32_16x16x64_bf16 v[236:239], a[4:7], a[184:191], v183
    v_smfmac_f32_16x16x64_bf16 v[212:215], a[0:3], a[80:87], v183
    s_nop 1
    v_pk_add_f32 v[224:225], v[224:225], v[226:227]
    v_smfmac_f32_16x16x64_bf16 v[212:215], a[4:7], a[88:95], v183
    v_add_f32 v224, v224, v225
    s_nop 1
    v_permlane16_swap_b32 v220, v224
    v_smfmac_f32_16x16x64_bf16 v[228:231], a[0:3], a[144:151], v183
    v_add_f32 v220, v220, v224
    v_mul_f32 v220, v48, v220
    v_pk_add_f32 v[236:237], v[236:237], v[238:239]
    v_smfmac_f32_16x16x64_bf16 v[228:231], a[4:7], a[152:159], v183
    v_permlane16_swap_b32 v220, v52
    v_add_f32 v236, v236, v237
    v_pk_add_f32 v[212:213], v[212:213], v[214:215]
    v_mov_b32_dpp v220, v216 row_ror:8 row_mask:0xa bank_mask:0xf
    v_cvt_pk_bf16_f32 v17, v216, v220
    v_mov_b32_dpp v53, v236 row_ror:8 row_mask:0xf bank_mask:0xf
    v_add_f32 v212, v212, v213
    s_nop 0
    v_pk_add_f32 v[228:229], v[228:229], v[230:231]
    v_permlane16_swap_b32 v212, v236
    v_add_f32 v212, v212, v236
    v_mul_f32 v212, v48, v212
    v_cvt_pk_bf16_f32 v16, v208, v212
    v_bitop3_b32 v19, v16, v17, v50 bitop3:0x96
    v_add_f32 v228, v228, v229
    s_nop 1
    v_permlane16_swap_b32 v228, v53
    v_add_f32 v228, v228, v53
    v_mul_f32 v228, v48, v228
    v_cvt_pk_bf16_f32 v18, v52, v228
    v_xor_b32 v19, v19, v18
    buffer_store_dwordx4 v[16:19], v6, s[56:59], 0 offen sc1
    s_cmp_eq_u32 s76, 1
    s_cbranch_scc1 L_H2
    s_endpgm
L_H:
    s_mov_b32 s78, 0
    v_lshlrev_b32 v31, 4, v0
    s_bfe_u32 s62, s2, 0x10003
    s_mul_i32 s62, s62, 73728
    s_add_u32 s62, s62, s97
    s_add_u32 s36, s26, s62
    s_addc_u32 s37, s27, 0
    s_mov_b32 s38, 73728
    s_mov_b32 s63, 0
L_hpf:
    buffer_load_dwordx4 v[244:247], v31, s[36:39], s63 offen
    s_waitcnt vmcnt(8)
    s_add_u32 s63, s63, 4096
    s_cmp_lt_u32 s63, 73728
    s_cbranch_scc1 L_hpf
    s_mov_b32 s77, 0
L_hdma:
    s_mov_b32 m0, s79
    s_add_u32 s79, s79, 4096
    buffer_load_dwordx4 v160, s[52:55], s78 offen lds
    s_add_u32 s78, s78, 36864
    s_cmp_ge_u32 s78, 147456
    s_cselect_b32 s62, 147328, 0
    s_sub_u32 s78, s78, s62
    s_add_u32 s77, s77, 1
    s_waitcnt vmcnt(8)
    s_cmp_lt_u32 s77, 36
    s_cbranch_scc1 L_hdma
    s_add_u32 s96, s61, 0
    s_bfe_u32 s66, s96, 262144
    s_lshl_b32 s66, s66, 11
    s_bfe_u32 s34, s96, 327684
    s_lshl_b32 s34, s34, 16
    s_or_b32 s66, s66, s34
    s_and_b32 s66, s66, 524287
    buffer_load_dwordx4 a[64:67], v4, s[44:47], s66 offen offset:0 nt
    buffer_load_dwordx4 a[68:71], v4, s[44:47], s66 offen offset:256 nt
    buffer_load_dwordx4 a[72:75], v4, s[44:47], s66 offen offset:1024 nt
    buffer_load_dwordx4 a[76:79], v4, s[44:47], s66 offen offset:1280 nt
    s_add_u32 s96, s61, 4
    s_bfe_u32 s66, s96, 262144
    s_lshl_b32 s66, s66, 11
    s_bfe_u32 s34, s96, 327684
    s_lshl_b32 s34, s34, 16
    s_or_b32 s66, s66, s34
    s_and_b32 s66, s66, 524287
    buffer_load_dwordx4 a[80:83], v4, s[44:47], s66 offen offset:0 nt
    buffer_load_dwordx4 a[84:87], v4, s[44:47], s66 offen offset:256 nt
    buffer_load_dwordx4 a[88:91], v4, s[44:47], s66 offen offset:1024 nt
    buffer_load_dwordx4 a[92:95], v4, s[44:47], s66 offen offset:1280 nt
    s_add_u32 s96, s61, 8
    s_bfe_u32 s66, s96, 262144
    s_lshl_b32 s66, s66, 11
    s_bfe_u32 s34, s96, 327684
    s_lshl_b32 s34, s34, 16
    s_or_b32 s66, s66, s34
    s_and_b32 s66, s66, 524287
    buffer_load_dwordx4 a[96:99], v4, s[44:47], s66 offen offset:0 nt
    buffer_load_dwordx4 a[100:103], v4, s[44:47], s66 offen offset:256 nt
    buffer_load_dwordx4 a[104:107], v4, s[44:47], s66 offen offset:1024 nt
    buffer_load_dwordx4 a[108:111], v4, s[44:47], s66 offen offset:1280 nt
    s_add_u32 s96, s61, 12
    s_bfe_u32 s66, s96, 262144
    s_lshl_b32 s66, s66, 11
    s_bfe_u32 s34, s96, 327684
    s_lshl_b32 s34, s34, 16
    s_or_b32 s66, s66, s34
    s_and_b32 s66, s66, 524287
    buffer_load_dwordx4 a[112:115], v4, s[44:47], s66 offen offset:0 nt
    buffer_load_dwordx4 a[116:119], v4, s[44:47], s66 offen offset:256 nt
    buffer_load_dwordx4 a[120:123], v4, s[44:47], s66 offen offset:1024 nt
    buffer_load_dwordx4 a[124:127], v4, s[44:47], s66 offen offset:1280 nt
    s_add_u32 s96, s61, 0
    s_bfe_u32 s66, s96, 262144
    s_lshl_b32 s66, s66, 11
    s_bfe_u32 s34, s96, 327684
    s_lshl_b32 s34, s34, 16
    s_or_b32 s66, s66, s34
    s_and_b32 s66, s66, 524287
    buffer_load_dwordx4 v[96:99], v5, s[48:51], s66 offen offset:0 nt
    buffer_load_dwordx4 v[100:103], v5, s[48:51], s66 offen offset:256 nt
    buffer_load_dwordx4 v[104:107], v5, s[48:51], s66 offen offset:1024 nt
    buffer_load_dwordx4 v[108:111], v5, s[48:51], s66 offen offset:1280 nt
    s_add_u32 s96, s61, 4
    s_bfe_u32 s66, s96, 262144
    s_lshl_b32 s66, s66, 11
    s_bfe_u32 s34, s96, 327684
    s_lshl_b32 s34, s34, 16
    s_or_b32 s66, s66, s34
    s_and_b32 s66, s66, 524287
    buffer_load_dwordx4 v[112:115], v5, s[48:51], s66 offen offset:0 nt
    buffer_load_dwordx4 v[116:119], v5, s[48:51], s66 offen offset:256 nt
    buffer_load_dwordx4 v[120:123], v5, s[48:51], s66 offen offset:1024 nt
    buffer_load_dwordx4 v[124:127], v5, s[48:51], s66 offen offset:1280 nt
    s_add_u32 s96, s61, 8
    s_bfe_u32 s66, s96, 262144
    s_lshl_b32 s66, s66, 11
    s_bfe_u32 s34, s96, 327684
    s_lshl_b32 s34, s34, 16
    s_or_b32 s66, s66, s34
    s_and_b32 s66, s66, 524287
    buffer_load_dwordx4 v[128:131], v5, s[48:51], s66 offen offset:0 nt
    buffer_load_dwordx4 v[132:135], v5, s[48:51], s66 offen offset:256 nt
    buffer_load_dwordx4 v[136:139], v5, s[48:51], s66 offen offset:1024 nt
    buffer_load_dwordx4 v[140:143], v5, s[48:51], s66 offen offset:1280 nt
    s_add_u32 s96, s61, 12
    s_bfe_u32 s66, s96, 262144
    s_lshl_b32 s66, s66, 11
    s_bfe_u32 s34, s96, 327684
    s_lshl_b32 s34, s34, 16
    s_or_b32 s66, s66, s34
    s_and_b32 s66, s66, 524287
    buffer_load_dwordx4 v[144:147], v5, s[48:51], s66 offen offset:0 nt
    buffer_load_dwordx4 v[148:151], v5, s[48:51], s66 offen offset:256 nt
    buffer_load_dwordx4 v[152:155], v5, s[48:51], s66 offen offset:1024 nt
    buffer_load_dwordx4 v[156:159], v5, s[48:51], s66 offen offset:1280 nt
    s_call_b64 s[4:5], L_AQ
    s_waitcnt vmcnt(0)
    s_call_b64 s[4:5], L_AK
    s_call_b64 s[4:5], L_AV0
    s_call_b64 s[4:5], L_AV1
    s_lshr_b32 s62, s67, 1
    s_and_b32 s63, s67, 1
    s_mul_i32 s64, s62, 1024
    s_lshl_b32 s65, s63, 6
    s_add_u32 s64, s64, s65
    s_add_u32 s64, s64, 397312
    v_mov_b32 v11, 128
    v_and_b32 v10, 7, v1
    v_mad_u32_u24 v96, v10, v11, s64
    v_lshrrev_b32 v10, 5, v0
    v_mad_u32_u24 v97, v10, v11, s64
    s_mul_i32 s64, s62, 8192
    s_lshl_b32 s65, s63, 9
    s_add_u32 s64, s64, s65
    s_add_u32 s64, s64, 430080
    v_mov_b32 v11, 1024
    v_mad_u32_u24 v98, v10, v11, s64
    v_and_b32 v10, 31, v1
    v_lshl_add_u32 v98, v10, 4, v98
    s_waitcnt vmcnt(0)
    s_barrier
    s_call_b64 s[4:5], L_T1
    s_mov_b32 s35, 0x8000
L_hp:
    s_sleep 127
    s_sleep 127
    s_sleep 127
    buffer_load_dwordx4 v[100:103], v96, s[56:59], 0 offen sc1
    buffer_load_dwordx4 v[104:107], v97, s[56:59], 0 offen sc1
    buffer_load_dwordx4 v[108:111], v98, s[56:59], 0 offen sc1
    s_sub_u32 s35, s35, 1
    s_waitcnt vmcnt(0)
    s_cbranch_scc1 L_hp1
    v_bitop3_b32 v102, v100, v102, s7 bitop3:0x96
    v_bitop3_b32 v103, v101, v103, s7 bitop3:0x96
    v_bitop3_b32 v106, v104, v106, s7 bitop3:0x96
    v_bitop3_b32 v107, v105, v107, s7 bitop3:0x96
    v_bitop3_b32 v110, v108, v110, s7 bitop3:0x96
    v_bitop3_b32 v111, v109, v111, s7 bitop3:0x96
    v_or3_b32 v10, v102, v103, v106
    v_or3_b32 v11, v107, v110, v111
    v_or_b32 v10, v10, v11
    v_cmp_ne_u32 vcc, 0, v10
    s_cbranch_vccz L_hp1
    s_branch L_hp
L_hp1:
    v_max_f32_dpp v12, v100, v100 row_ror:4 row_mask:0xf bank_mask:0xf
    s_nop 1
    v_max_f32_dpp v11, v12, v12 row_ror:2 row_mask:0xf bank_mask:0xf
    s_nop 1
    v_max_f32_dpp v12, v11, v11 row_ror:1 row_mask:0xf bank_mask:0xf
    s_nop 1
    v_sub_f32 v11, v100, v12
    v_sub_f32 v104, v104, v12
    v_exp_f32 v11, v11
    v_exp_f32 v104, v104
    v_lshlrev_b32 v32, 16, v108
    v_and_b32 v33, 0xffff0000, v108
    v_lshlrev_b32 v34, 16, v109
    v_and_b32 v35, 0xffff0000, v109
    v_mul_f32 v11, v11, v101
    v_mul_f32 v32, v104, v32
    v_mul_f32 v33, v104, v33
    v_mul_f32 v34, v104, v34
    v_mul_f32 v35, v104, v35
    v_add_f32_dpp v13, v11, v11 row_ror:4 row_mask:0xf bank_mask:0xf
    s_nop 1
    v_add_f32_dpp v11, v13, v13 row_ror:2 row_mask:0xf bank_mask:0xf
    s_nop 1
    v_add_f32_dpp v13, v11, v11 row_ror:1 row_mask:0xf bank_mask:0xf
    s_nop 1
    v_mul_f32 v13, 0x3d800000, v13
    v_mov_b32 v36, v32
    v_mov_b32 v37, v33
    v_mov_b32 v38, v34
    v_mov_b32 v39, v35
    s_nop 1
    v_permlane32_swap_b32 v32, v36
    v_permlane32_swap_b32 v33, v37
    v_permlane32_swap_b32 v34, v38
    v_permlane32_swap_b32 v35, v39
    s_nop 1
    v_add_f32 v32, v32, v36
    v_add_f32 v33, v33, v37
    v_add_f32 v34, v34, v38
    v_add_f32 v35, v35, v39
    s_branch L_T2
L_H2:
    s_waitcnt vmcnt(0)
    s_barrier
    s_cmp_lt_u32 s2, 232
    s_cselect_b32 s45, 1, 0
    s_cmp_lg_u32 s3, 0
    s_cbranch_scc1 L_H3
    s_lshl_b32 s62, s2, 2
    s_add_u32 s62, s62, -512
    v_mov_b32 v152, s7
    s_mov_b64 exec, 1
    buffer_store_dword v152, off, s[56:59], s62 sc1
    s_mov_b64 exec, -1
    s_cmp_eq_u32 s45, 1
    s_cbranch_scc1 L_H3
    s_mov_b32 s35, 0x40000
L_hf:
    s_sleep 100
    buffer_load_dword v153, v163, s[56:59], 0 offen offset:256 sc1
    s_sub_u32 s35, s35, 1
    s_waitcnt vmcnt(0)
    s_cbranch_scc1 L_H3
    v_cmp_ne_u32 vcc, s7, v153
    s_cbranch_vccnz L_hf
    s_cmp_lg_u32 s2, 255
    s_cbranch_scc1 L_H3
    v_mov_b32 v153, s6
    s_mov_b64 exec, 1
    buffer_store_dword v153, off, s[56:59], 0 sc1
    s_mov_b64 exec, -1
L_H3:
    s_mul_i32 s62, s45, 40
    s_add_u32 s64, s2, s62
    s_sub_u32 s64, s64, 232
    s_cmp_ge_u32 s64, 24
    s_cbranch_scc1 L_done
    s_cmp_ge_u32 s64, 12
    s_cselect_b32 s63, 1, 0
    s_cselect_b32 s65, 12, 0
    s_sub_u32 s64, s64, s65
    s_lshl_b32 s65, s63, 5
    v_lshrrev_b32 v10, 3, v0
    v_add_u32 v10, s65, v10
    s_lshl1_add_u32 s65, s45, 1
    v_mul_u32_u24 v10, s65, v10
    s_cmp_eq_u32 s45, 0
    s_cselect_b32 s65, 192, 0
    v_add_u32 v10, s65, v10
    v_and_b32 v11, 7, v0
    s_lshl_b32 s65, s64, 7
    s_add_u32 s65, s65, 2048
    v_mov_b32 v196, 1536
    v_mad_u32_u24 v196, v10, v196, s65
    v_lshl_add_u32 v196, v11, 4, v196
    s_lshl_b32 s65, s3, 8
    s_add_u32 s65, s65, 152000
    v_lshl_add_u32 v197, v11, 2, s65
    v_lshrrev_b32 v10, 1, v2
    v_lshl_add_u32 v197, v10, 5, v197
    v_and_b32 v10, 1, v2
    v_lshl_add_u32 v198, v10, 6, v197
    v_lshlrev_b32 v199, 2, v0
    v_add_u32 v199, 152000, v199
    s_mul_i32 s63, s63, 1152
    s_mul_i32 s62, s45, 576
    s_add_u32 s63, s63, s62
    s_mul_i32 s62, s64, 11
    s_lshr_b32 s62, s62, 5
    s_lshl4_add_u32 s63, s62, s63
    s_mul_i32 s62, s62, 3
    s_sub_u32 s64, s64, s62
    s_mov_b32 s62, 0x18100800
    s_mov_b32 s65, 0x2820
    s_cmp_eq_u32 s64, 2
    s_cselect_b32 s62, 0x41403830, s62
    s_cselect_b32 s65, 0x3931, s65
    s_cselect_b32 s64, 0, s64
    s_lshl3_add_u32 s63, s64, s63
    v_bfe_u32 v10, v0, 3, 3
    v_or_b32 v10, 0x0c0c0c00, v10
    v_mov_b32 v200, s65
    v_perm_b32 v200, v200, s62, v10
    v_lshl_add_u32 v200, v200, 3, v11
    v_add_lshl_u32 v200, v200, s63, 1
    s_mov_b32 s35, 0x100000
    s_cmp_eq_u32 s45, 0
    s_cbranch_scc1 L_finA
    s_and_b32 s65, s2, 15
    s_lshl_b32 s65, s65, 7
    s_add_u32 s65, s65, 395264
    v_lshlrev_b32 v11, 3, v1
    s_mov_b64 exec, 0xff
    buffer_load_dwordx2 v[16:17], v11, s[56:59], s65 offen sc1
    s_mov_b64 exec, -1
    buffer_load_dword v180, v163, s[56:59], 0 offen offset:1024
    s_waitcnt vmcnt(0)
    v_xor_b32 v17, v16, v17
    v_subrev_u32 v16, s94, v16
    v_cmp_ne_u32 s[64:65], s7, v17
    s_nop 1
    v_add_u32_dpp v16, v16, v16 quad_perm:[1,0,3,2] row_mask:0xf bank_mask:0xf
    s_nop 1
    v_add_u32_dpp v16, v16, v16 quad_perm:[2,3,0,1] row_mask:0xf bank_mask:0xf
    s_nop 1
    v_add_u32_dpp v16, v16, v16 row_half_mirror row_mask:0xf bank_mask:0xf
    s_nop 1
    v_readfirstlane_b32 s62, v16
    s_and_b32 s64, s64, 0xff
    s_cselect_b32 s62, 0, s62
    s_ashr_i32 s62, s62, 3
    s_add_u32 s18, s94, s62
    s_add_u32 s18, s18, 4475
    s_mov_b32 s20, s18
    s_mov_b32 s18, 0
    s_mov_b32 s23, 0
    s_call_b64 s[4:5], L_LA
    s_mul_i32 s18, s18, 4
    s_ashr_i32 s18, s18, 6
    s_add_u32 s18, s18, s20
    s_mov_b32 exec_lo, 983055
    s_mov_b32 exec_hi, 983055
L_pollc:
    s_sleep 2
    buffer_load_dwordx4 v[64:67], v196, s[56:59], 0 offen offset:3072 sc1
    s_memrealtime s[20:21]
    s_sub_u32 s35, s35, 1
    s_cbranch_scc1 L_pollc_done
    s_waitcnt lgkmcnt(0)
    s_sub_u32 s62, s20, s18
    s_cmp_ge_i32 s62, 0
    s_cbranch_scc1 L_pollc_done
    s_waitcnt vmcnt(0)
    v_bitop3_b32 v48, v64, v65, v66 bitop3:0x96
    v_bitop3_b32 v57, v48, v67, v182 bitop3:0x96
    s_nop 1
    v_xor_b32_dpp v48, v57, v57 quad_perm:[1,0,3,2] row_mask:0xf bank_mask:0xf
    v_xor_b32_dpp v51, v57, v57 quad_perm:[2,3,0,1] row_mask:0xf bank_mask:0xf
    v_or_b32 v48, v48, v51
    v_cmp_eq_u32 vcc, 0, v48
    s_bcnt1_i32_b64 s64, vcc
    s_cmp_lt_u32 s64, 12
    s_cbranch_scc1 L_pollc
L_pollc_done:
    s_mov_b64 exec, -1
    s_mov_b32 s35, 0x100000
    s_mov_b64 s[22:23], -1
    s_mov_b64 s[24:25], -1
    s_mov_b64 s[26:27], -1
    buffer_load_dwordx4 v[64:67], v196, s[56:59], 0 offen offset:0 sc1
    buffer_load_dwordx4 v[68:71], v196, s[56:59], 0 offen offset:1536 sc1
    buffer_load_dwordx4 v[72:75], v196, s[56:59], 0 offen offset:3072 sc1
    s_mov_b64 exec, -1
    s_sleep 8
L_polld:
    s_or_b64 exec, s[22:23], 1
    buffer_load_dwordx4 v[84:87], v196, s[56:59], 0 offen offset:0 sc1
    s_or_b64 exec, s[24:25], 1
    buffer_load_dwordx4 v[88:91], v196, s[56:59], 0 offen offset:1536 sc1
    s_or_b64 exec, s[26:27], 1
    buffer_load_dwordx4 v[92:95], v196, s[56:59], 0 offen offset:3072 sc1
    s_mov_b64 exec, -1
    s_waitcnt vmcnt(3)
    v_bitop3_b32 v48, v64, v65, v66 bitop3:0x96
    v_bitop3_b32 v49, v68, v69, v70 bitop3:0x96
    v_bitop3_b32 v50, v72, v73, v74 bitop3:0x96
    v_bitop3_b32 v57, v48, v67, v182 bitop3:0x96
    v_bitop3_b32 v58, v49, v71, v182 bitop3:0x96
    v_bitop3_b32 v59, v50, v75, v182 bitop3:0x96
    v_xor_b32_dpp v48, v57, v57 quad_perm:[1,0,3,2] row_mask:0xf bank_mask:0xf
    v_xor_b32_dpp v49, v58, v58 quad_perm:[1,0,3,2] row_mask:0xf bank_mask:0xf
    v_xor_b32_dpp v50, v59, v59 quad_perm:[1,0,3,2] row_mask:0xf bank_mask:0xf
    v_xor_b32_dpp v51, v57, v57 quad_perm:[2,3,0,1] row_mask:0xf bank_mask:0xf
    v_xor_b32_dpp v52, v58, v58 quad_perm:[2,3,0,1] row_mask:0xf bank_mask:0xf
    v_xor_b32_dpp v53, v59, v59 quad_perm:[2,3,0,1] row_mask:0xf bank_mask:0xf
    v_or_b32 v48, v48, v51
    v_or_b32 v49, v49, v52
    v_or_b32 v50, v50, v53
    v_max3_f32 v56, v57, v58, v59
    v_or3_b32 v51, v48, v49, v50
    v_sub_f32 v57, v57, v56
    v_sub_f32 v58, v58, v56
    v_sub_f32 v59, v59, v56
    v_cmp_ne_u32 vcc, 0, v51
    v_exp_f32 v57, v57
    v_exp_f32 v58, v58
    v_exp_f32 v59, v59
    s_cbranch_vccz L_polld_done0
    v_cmp_ne_u32 s[16:17], 0, v48
    v_cmp_ne_u32 s[18:19], 0, v49
    v_cmp_ne_u32 s[20:21], 0, v50
    s_or_b64 exec, s[16:17], 1
    buffer_load_dwordx4 v[64:67], v196, s[56:59], 0 offen offset:0 sc1
    s_or_b64 exec, s[18:19], 1
    buffer_load_dwordx4 v[68:71], v196, s[56:59], 0 offen offset:1536 sc1
    s_or_b64 exec, s[20:21], 1
    buffer_load_dwordx4 v[72:75], v196, s[56:59], 0 offen offset:3072 sc1
    s_mov_b64 exec, -1
    s_waitcnt vmcnt(3)
    v_bitop3_b32 v48, v84, v85, v86 bitop3:0x96
    v_bitop3_b32 v49, v88, v89, v90 bitop3:0x96
    v_bitop3_b32 v50, v92, v93, v94 bitop3:0x96
    v_bitop3_b32 v57, v48, v87, v182 bitop3:0x96
    v_bitop3_b32 v58, v49, v91, v182 bitop3:0x96
    v_bitop3_b32 v59, v50, v95, v182 bitop3:0x96
    v_xor_b32_dpp v48, v57, v57 quad_perm:[1,0,3,2] row_mask:0xf bank_mask:0xf
    v_xor_b32_dpp v49, v58, v58 quad_perm:[1,0,3,2] row_mask:0xf bank_mask:0xf
    v_xor_b32_dpp v50, v59, v59 quad_perm:[1,0,3,2] row_mask:0xf bank_mask:0xf
    v_xor_b32_dpp v51, v57, v57 quad_perm:[2,3,0,1] row_mask:0xf bank_mask:0xf
    v_xor_b32_dpp v52, v58, v58 quad_perm:[2,3,0,1] row_mask:0xf bank_mask:0xf
    v_xor_b32_dpp v53, v59, v59 quad_perm:[2,3,0,1] row_mask:0xf bank_mask:0xf
    v_or_b32 v48, v48, v51
    v_or_b32 v49, v49, v52
    v_or_b32 v50, v50, v53
    v_max3_f32 v56, v57, v58, v59
    v_or3_b32 v51, v48, v49, v50
    v_sub_f32 v57, v57, v56
    v_sub_f32 v58, v58, v56
    v_sub_f32 v59, v59, v56
    v_cmp_ne_u32 vcc, 0, v51
    v_exp_f32 v57, v57
    v_exp_f32 v58, v58
    v_exp_f32 v59, v59
    s_cbranch_vccz L_polld_done1
    v_cmp_ne_u32 s[22:23], 0, v48
    v_cmp_ne_u32 s[24:25], 0, v49
    v_cmp_ne_u32 s[26:27], 0, v50
    s_sub_u32 s35, s35, 1
    s_cbranch_scc0 L_polld
L_polld_done1:
    v_add_f32 v56, v57, v58
    v_lshlrev_b32 v76, 16, v84
    v_and_b32 v77, 0xffff0000, v84
    v_lshlrev_b32 v78, 16, v85
    v_and_b32 v79, 0xffff0000, v85
    v_lshlrev_b32 v80, 16, v86
    v_and_b32 v81, 0xffff0000, v86
    v_add_f32 v56, v56, v59
    v_lshlrev_b32 v120, 16, v88
    v_and_b32 v121, 0xffff0000, v88
    v_lshlrev_b32 v122, 16, v89
    v_and_b32 v123, 0xffff0000, v89
    v_lshlrev_b32 v124, 16, v90
    v_and_b32 v125, 0xffff0000, v90
    v_rcp_f32 v56, v56
    v_lshlrev_b32 v126, 16, v92
    v_and_b32 v127, 0xffff0000, v92
    v_lshlrev_b32 v128, 16, v93
    v_and_b32 v129, 0xffff0000, v93
    v_lshlrev_b32 v130, 16, v94
    v_and_b32 v131, 0xffff0000, v94
    s_branch L_fin1
L_polld_done0:
    v_add_f32 v56, v57, v58
    v_lshlrev_b32 v76, 16, v64
    v_and_b32 v77, 0xffff0000, v64
    v_lshlrev_b32 v78, 16, v65
    v_and_b32 v79, 0xffff0000, v65
    v_lshlrev_b32 v80, 16, v66
    v_and_b32 v81, 0xffff0000, v66
    v_add_f32 v56, v56, v59
    v_lshlrev_b32 v120, 16, v68
    v_and_b32 v121, 0xffff0000, v68
    v_lshlrev_b32 v122, 16, v69
    v_and_b32 v123, 0xffff0000, v69
    v_lshlrev_b32 v124, 16, v70
    v_and_b32 v125, 0xffff0000, v70
    v_rcp_f32 v56, v56
    v_lshlrev_b32 v126, 16, v72
    v_and_b32 v127, 0xffff0000, v72
    v_lshlrev_b32 v128, 16, v73
    v_and_b32 v129, 0xffff0000, v73
    v_lshlrev_b32 v130, 16, v74
    v_and_b32 v131, 0xffff0000, v74
L_fin1:
    v_mul_f32 v48, v57, v56
    v_mul_f32 v50, v58, v56
    v_mul_f32 v52, v59, v56
    v_pk_mul_f32 v[76:77], v[76:77], v[48:49] op_sel_hi:[1,0]
    v_pk_mul_f32 v[78:79], v[78:79], v[48:49] op_sel_hi:[1,0]
    v_pk_mul_f32 v[80:81], v[80:81], v[48:49] op_sel_hi:[1,0]
    v_pk_fma_f32 v[76:77], v[120:121], v[50:51], v[76:77] op_sel_hi:[1,0,1]
    v_pk_fma_f32 v[78:79], v[122:123], v[50:51], v[78:79] op_sel_hi:[1,0,1]
    v_pk_fma_f32 v[80:81], v[124:125], v[50:51], v[80:81] op_sel_hi:[1,0,1]
    v_pk_fma_f32 v[76:77], v[126:127], v[52:53], v[76:77] op_sel_hi:[1,0,1]
    v_pk_fma_f32 v[78:79], v[128:129], v[52:53], v[78:79] op_sel_hi:[1,0,1]
    v_pk_fma_f32 v[80:81], v[130:131], v[52:53], v[80:81] op_sel_hi:[1,0,1]
L_fin2:
    v_add_f32_dpp v40, v76, v76 row_ror:8 row_mask:0xf bank_mask:0xf
    v_add_f32_dpp v41, v77, v77 row_ror:8 row_mask:0xf bank_mask:0xf
    v_add_f32_dpp v42, v78, v78 row_ror:8 row_mask:0xf bank_mask:0xf
    v_add_f32_dpp v43, v79, v79 row_ror:8 row_mask:0xf bank_mask:0xf
    v_add_f32_dpp v44, v80, v80 row_ror:8 row_mask:0xf bank_mask:0xf
    v_add_f32_dpp v45, v81, v81 row_ror:8 row_mask:0xf bank_mask:0xf
    v_permlane32_swap_b32 v40, v41
    v_permlane32_swap_b32 v42, v43
    v_permlane32_swap_b32 v44, v45
    v_add_f32 v44, v44, v45
    v_add_f32 v40, v40, v41
    v_add_f32 v42, v42, v43
    v_mov_b32 v45, v44
    s_nop 0
    v_permlane16_swap_b32 v40, v42
    v_permlane16_swap_b32 v44, v45
    v_add_f32 v40, v40, v42
    v_add_f32 v44, v44, v45
    ds_write_b32 v198, v40
    ds_write_b32 v197, v44 offset:128
    s_cmp_lg_u32 s3, 0
    s_mov_b32 exec_hi, 0xffff
    s_waitcnt lgkmcnt(0)
    s_barrier
    s_cbranch_scc1 L_done0
    ds_read_b32 v40, v199 offset:0
    ds_read_b32 v41, v199 offset:256
    ds_read_b32 v42, v199 offset:512
    ds_read_b32 v43, v199 offset:768
    s_waitcnt lgkmcnt(0)
    v_add_f32 v40, v40, v41
    v_add_f32 v42, v42, v43
    v_add_f32 v40, v40, v42
    v_cvt_pk_bf16_f32 v40, v40, v40
    buffer_store_short v40, v200, s[12:15], 0 offen
L_done0:
    s_mov_b64 exec, -1
L_done:
L_exit:
    s_endpgm
L_finA:
    s_barrier
    buffer_load_dwordx4 v[120:123], v196, s[56:59], 0 offen sc1
    s_waitcnt vmcnt(0)
    v_lshlrev_b32 v76, 16, v120
    v_and_b32 v77, 0xffff0000, v120
    v_lshlrev_b32 v78, 16, v121
    v_and_b32 v79, 0xffff0000, v121
    v_lshlrev_b32 v80, 16, v122
    v_and_b32 v81, 0xffff0000, v122
    s_nop 0
    s_branch L_fin2
L_AQ:
    buffer_load_dwordx4 v[208:211], v161, s[56:59], s100 offen offset:0
    buffer_load_dwordx4 v[212:215], v161, s[56:59], s100 offen offset:256
    buffer_load_dwordx4 v[216:219], v161, s[56:59], s100 offen offset:512
    buffer_load_dwordx4 v[220:223], v161, s[56:59], s100 offen offset:768
    buffer_load_dwordx4 v[224:227], v161, s[56:59], s100 offen offset:1024
    buffer_load_dwordx4 v[228:231], v161, s[56:59], s100 offen offset:1280
    buffer_load_dwordx4 v[232:235], v161, s[56:59], s100 offen offset:1536
    buffer_load_dwordx4 v[236:239], v161, s[56:59], s100 offen offset:1792
    s_setpc_b64 s[4:5]
L_AK:
    v_bitop3_b32 v216, v208, v216, s7 bitop3:0x96
    v_bitop3_b32 v217, v209, v217, s7 bitop3:0x96
    v_bitop3_b32 v218, v210, v218, s7 bitop3:0x96
    v_bitop3_b32 v219, v211, v219, s7 bitop3:0x96
    v_bitop3_b32 v220, v212, v220, s7 bitop3:0x96
    v_bitop3_b32 v221, v213, v221, s7 bitop3:0x96
    v_bitop3_b32 v222, v214, v222, s7 bitop3:0x96
    v_bitop3_b32 v223, v215, v223, s7 bitop3:0x96
    v_bitop3_b32 v232, v224, v232, s7 bitop3:0x96
    v_bitop3_b32 v233, v225, v233, s7 bitop3:0x96
    v_bitop3_b32 v234, v226, v234, s7 bitop3:0x96
    v_bitop3_b32 v235, v227, v235, s7 bitop3:0x96
    v_bitop3_b32 v236, v228, v236, s7 bitop3:0x96
    v_bitop3_b32 v237, v229, v237, s7 bitop3:0x96
    v_bitop3_b32 v238, v230, v238, s7 bitop3:0x96
    v_bitop3_b32 v239, v231, v239, s7 bitop3:0x96
    v_or_b32 v10, v216, v217
    v_or3_b32 v10, v10, v218, v219
    v_or3_b32 v10, v10, v220, v221
    v_or3_b32 v10, v10, v222, v223
    v_or3_b32 v10, v10, v232, v233
    v_or3_b32 v10, v10, v234, v235
    v_or3_b32 v10, v10, v236, v237
    v_or3_b32 v10, v10, v238, v239
    v_cmp_ne_u32 vcc, 0, v10
    s_cbranch_vccz L_qokA
    s_mov_b32 s35, 0x40000
L_qretryA:
    buffer_load_dwordx4 v[208:211], v161, s[56:59], s100 offen offset:0 sc1
    buffer_load_dwordx4 v[212:215], v161, s[56:59], s100 offen offset:256 sc1
    buffer_load_dwordx4 v[216:219], v161, s[56:59], s100 offen offset:512 sc1
    buffer_load_dwordx4 v[220:223], v161, s[56:59], s100 offen offset:768 sc1
    buffer_load_dwordx4 v[224:227], v161, s[56:59], s100 offen offset:1024 sc1
    buffer_load_dwordx4 v[228:231], v161, s[56:59], s100 offen offset:1280 sc1
    buffer_load_dwordx4 v[232:235], v161, s[56:59], s100 offen offset:1536 sc1
    buffer_load_dwordx4 v[236:239], v161, s[56:59], s100 offen offset:1792 sc1
    s_sub_u32 s35, s35, 1
    s_waitcnt vmcnt(0)
    s_cbranch_scc1 L_qokA
    v_bitop3_b32 v216, v208, v216, s7 bitop3:0x96
    v_bitop3_b32 v217, v209, v217, s7 bitop3:0x96
    v_bitop3_b32 v218, v210, v218, s7 bitop3:0x96
    v_bitop3_b32 v219, v211, v219, s7 bitop3:0x96
    v_bitop3_b32 v220, v212, v220, s7 bitop3:0x96
    v_bitop3_b32 v221, v213, v221, s7 bitop3:0x96
    v_bitop3_b32 v222, v214, v222, s7 bitop3:0x96
    v_bitop3_b32 v223, v215, v223, s7 bitop3:0x96
    v_bitop3_b32 v232, v224, v232, s7 bitop3:0x96
    v_bitop3_b32 v233, v225, v233, s7 bitop3:0x96
    v_bitop3_b32 v234, v226, v234, s7 bitop3:0x96
    v_bitop3_b32 v235, v227, v235, s7 bitop3:0x96
    v_bitop3_b32 v236, v228, v236, s7 bitop3:0x96
    v_bitop3_b32 v237, v229, v237, s7 bitop3:0x96
    v_bitop3_b32 v238, v230, v238, s7 bitop3:0x96
    v_bitop3_b32 v239, v231, v239, s7 bitop3:0x96
    v_or_b32 v10, v216, v217
    v_or3_b32 v10, v10, v218, v219
    v_or3_b32 v10, v10, v220, v221
    v_or3_b32 v10, v10, v222, v223
    v_or3_b32 v10, v10, v232, v233
    v_or3_b32 v10, v10, v234, v235
    v_or3_b32 v10, v10, v236, v237
    v_or3_b32 v10, v10, v238, v239
    v_cmp_ne_u32 vcc, 0, v10
    s_cbranch_vccnz L_qretryA
L_qokA:
    v_add_f32_dpp v216, v208, v208 row_ror:4 row_mask:0xf bank_mask:0xf
    v_add_f32_dpp v217, v209, v209 row_ror:4 row_mask:0xf bank_mask:0xf
    v_add_f32_dpp v218, v210, v210 row_ror:4 row_mask:0xf bank_mask:0xf
    v_add_f32_dpp v219, v211, v211 row_ror:4 row_mask:0xf bank_mask:0xf
    v_add_f32_dpp v220, v212, v212 row_ror:4 row_mask:0xf bank_mask:0xf
    v_add_f32_dpp v221, v213, v213 row_ror:4 row_mask:0xf bank_mask:0xf
    v_add_f32_dpp v222, v214, v214 row_ror:4 row_mask:0xf bank_mask:0xf
    v_add_f32_dpp v223, v215, v215 row_ror:4 row_mask:0xf bank_mask:0xf
    v_add_f32_dpp v232, v224, v224 row_ror:4 row_mask:0xf bank_mask:0xf
    v_add_f32_dpp v233, v225, v225 row_ror:4 row_mask:0xf bank_mask:0xf
    v_add_f32_dpp v234, v226, v226 row_ror:4 row_mask:0xf bank_mask:0xf
    v_add_f32_dpp v235, v227, v227 row_ror:4 row_mask:0xf bank_mask:0xf
    v_add_f32_dpp v236, v228, v228 row_ror:4 row_mask:0xf bank_mask:0xf
    v_add_f32_dpp v237, v229, v229 row_ror:4 row_mask:0xf bank_mask:0xf
    v_add_f32_dpp v238, v230, v230 row_ror:4 row_mask:0xf bank_mask:0xf
    v_add_f32_dpp v239, v231, v231 row_ror:4 row_mask:0xf bank_mask:0xf
    v_add_f32_dpp v208, v216, v216 row_ror:8 row_mask:0xf bank_mask:0x3
    v_add_f32_dpp v209, v217, v217 row_ror:8 row_mask:0xf bank_mask:0x3
    v_add_f32_dpp v210, v218, v218 row_ror:8 row_mask:0xf bank_mask:0x3
    v_add_f32_dpp v211, v219, v219 row_ror:8 row_mask:0xf bank_mask:0x3
    v_add_f32_dpp v212, v220, v220 row_ror:8 row_mask:0xf bank_mask:0x3
    v_add_f32_dpp v213, v221, v221 row_ror:8 row_mask:0xf bank_mask:0x3
    v_add_f32_dpp v214, v222, v222 row_ror:8 row_mask:0xf bank_mask:0x3
    v_add_f32_dpp v215, v223, v223 row_ror:8 row_mask:0xf bank_mask:0x3
    v_add_f32_dpp v208, v232, v232 row_ror:8 row_mask:0xf bank_mask:0xc
    v_add_f32_dpp v209, v233, v233 row_ror:8 row_mask:0xf bank_mask:0xc
    v_add_f32_dpp v210, v234, v234 row_ror:8 row_mask:0xf bank_mask:0xc
    v_add_f32_dpp v211, v235, v235 row_ror:8 row_mask:0xf bank_mask:0xc
    v_add_f32_dpp v212, v236, v236 row_ror:8 row_mask:0xf bank_mask:0xc
    v_add_f32_dpp v213, v237, v237 row_ror:8 row_mask:0xf bank_mask:0xc
    v_add_f32_dpp v214, v238, v238 row_ror:8 row_mask:0xf bank_mask:0xc
    v_add_f32_dpp v215, v239, v239 row_ror:8 row_mask:0xf bank_mask:0xc
    v_cvt_pk_bf16_f32 v68, v208, v209
    v_cvt_pk_bf16_f32 v69, v210, v211
    v_cvt_pk_bf16_f32 v70, v212, v213
    v_cvt_pk_bf16_f32 v71, v214, v215
    s_nop 1
    v_mfma_f32_16x16x32_bf16 v[48:51], a[64:67], v[68:71], 0
    v_mfma_f32_16x16x32_bf16 v[52:55], a[68:71], v[68:71], 0
    v_mfma_f32_16x16x32_bf16 v[56:59], a[72:75], v[68:71], 0
    v_mfma_f32_16x16x32_bf16 v[60:63], a[76:79], v[68:71], 0
    v_mfma_f32_16x16x32_bf16 v[72:75], a[80:83], v[68:71], 0
    v_mfma_f32_16x16x32_bf16 v[76:79], a[84:87], v[68:71], 0
    v_mfma_f32_16x16x32_bf16 v[80:83], a[88:91], v[68:71], 0
    v_mfma_f32_16x16x32_bf16 v[84:87], a[92:95], v[68:71], 0
    v_mfma_f32_16x16x32_bf16 v[208:211], a[96:99], v[68:71], 0
    v_mfma_f32_16x16x32_bf16 v[212:215], a[100:103], v[68:71], 0
    v_mfma_f32_16x16x32_bf16 v[216:219], a[104:107], v[68:71], 0
    v_mfma_f32_16x16x32_bf16 v[220:223], a[108:111], v[68:71], 0
    v_mfma_f32_16x16x32_bf16 v[224:227], a[112:115], v[68:71], 0
    v_mfma_f32_16x16x32_bf16 v[228:231], a[116:119], v[68:71], 0
    v_mfma_f32_16x16x32_bf16 v[232:235], a[120:123], v[68:71], 0
    v_mfma_f32_16x16x32_bf16 v[236:239], a[124:127], v[68:71], 0
    v_mov_b32_dpp v164, v48 quad_perm:[0,0,0,0] row_mask:0xf bank_mask:0xf
    v_mov_b32_dpp v165, v52 quad_perm:[0,0,0,0] row_mask:0xf bank_mask:0xf
    v_mov_b32_dpp v166, v56 quad_perm:[0,0,0,0] row_mask:0xf bank_mask:0xf
    v_mov_b32_dpp v167, v60 quad_perm:[0,0,0,0] row_mask:0xf bank_mask:0xf
    v_add_f32_dpp v164, v49, v164 quad_perm:[1,1,1,1] row_mask:0xf bank_mask:0xf
    v_add_f32_dpp v165, v53, v165 quad_perm:[1,1,1,1] row_mask:0xf bank_mask:0xf
    v_add_f32_dpp v166, v57, v166 quad_perm:[1,1,1,1] row_mask:0xf bank_mask:0xf
    v_add_f32_dpp v167, v61, v167 quad_perm:[1,1,1,1] row_mask:0xf bank_mask:0xf
    v_add_f32_dpp v164, v50, v164 quad_perm:[2,2,2,2] row_mask:0xf bank_mask:0xf
    v_add_f32_dpp v165, v54, v165 quad_perm:[2,2,2,2] row_mask:0xf bank_mask:0xf
    v_add_f32_dpp v166, v58, v166 quad_perm:[2,2,2,2] row_mask:0xf bank_mask:0xf
    v_add_f32_dpp v167, v62, v167 quad_perm:[2,2,2,2] row_mask:0xf bank_mask:0xf
    v_add_f32_dpp v164, v51, v164 quad_perm:[3,3,3,3] row_mask:0xf bank_mask:0xf
    v_add_f32_dpp v165, v55, v165 quad_perm:[3,3,3,3] row_mask:0xf bank_mask:0xf
    v_add_f32_dpp v166, v59, v166 quad_perm:[3,3,3,3] row_mask:0xf bank_mask:0xf
    v_add_f32_dpp v167, v63, v167 quad_perm:[3,3,3,3] row_mask:0xf bank_mask:0xf
    v_mov_b32_dpp v168, v72 quad_perm:[0,0,0,0] row_mask:0xf bank_mask:0xf
    v_mov_b32_dpp v169, v76 quad_perm:[0,0,0,0] row_mask:0xf bank_mask:0xf
    v_mov_b32_dpp v170, v80 quad_perm:[0,0,0,0] row_mask:0xf bank_mask:0xf
    v_mov_b32_dpp v171, v84 quad_perm:[0,0,0,0] row_mask:0xf bank_mask:0xf
    v_add_f32_dpp v168, v73, v168 quad_perm:[1,1,1,1] row_mask:0xf bank_mask:0xf
    v_add_f32_dpp v169, v77, v169 quad_perm:[1,1,1,1] row_mask:0xf bank_mask:0xf
    v_add_f32_dpp v170, v81, v170 quad_perm:[1,1,1,1] row_mask:0xf bank_mask:0xf
    v_add_f32_dpp v171, v85, v171 quad_perm:[1,1,1,1] row_mask:0xf bank_mask:0xf
    v_add_f32_dpp v168, v74, v168 quad_perm:[2,2,2,2] row_mask:0xf bank_mask:0xf
    v_add_f32_dpp v169, v78, v169 quad_perm:[2,2,2,2] row_mask:0xf bank_mask:0xf
    v_add_f32_dpp v170, v82, v170 quad_perm:[2,2,2,2] row_mask:0xf bank_mask:0xf
    v_add_f32_dpp v171, v86, v171 quad_perm:[2,2,2,2] row_mask:0xf bank_mask:0xf
    v_add_f32_dpp v168, v75, v168 quad_perm:[3,3,3,3] row_mask:0xf bank_mask:0xf
    v_add_f32_dpp v169, v79, v169 quad_perm:[3,3,3,3] row_mask:0xf bank_mask:0xf
    v_add_f32_dpp v170, v83, v170 quad_perm:[3,3,3,3] row_mask:0xf bank_mask:0xf
    v_add_f32_dpp v171, v87, v171 quad_perm:[3,3,3,3] row_mask:0xf bank_mask:0xf
    v_mov_b32_dpp v172, v208 quad_perm:[0,0,0,0] row_mask:0xf bank_mask:0xf
    v_mov_b32_dpp v173, v212 quad_perm:[0,0,0,0] row_mask:0xf bank_mask:0xf
    v_mov_b32_dpp v174, v216 quad_perm:[0,0,0,0] row_mask:0xf bank_mask:0xf
    v_mov_b32_dpp v175, v220 quad_perm:[0,0,0,0] row_mask:0xf bank_mask:0xf
    v_add_f32_dpp v172, v209, v172 quad_perm:[1,1,1,1] row_mask:0xf bank_mask:0xf
    v_add_f32_dpp v173, v213, v173 quad_perm:[1,1,1,1] row_mask:0xf bank_mask:0xf
    v_add_f32_dpp v174, v217, v174 quad_perm:[1,1,1,1] row_mask:0xf bank_mask:0xf
    v_add_f32_dpp v175, v221, v175 quad_perm:[1,1,1,1] row_mask:0xf bank_mask:0xf
    v_add_f32_dpp v172, v210, v172 quad_perm:[2,2,2,2] row_mask:0xf bank_mask:0xf
    v_add_f32_dpp v173, v214, v173 quad_perm:[2,2,2,2] row_mask:0xf bank_mask:0xf
    v_add_f32_dpp v174, v218, v174 quad_perm:[2,2,2,2] row_mask:0xf bank_mask:0xf
    v_add_f32_dpp v175, v222, v175 quad_perm:[2,2,2,2] row_mask:0xf bank_mask:0xf
    v_add_f32_dpp v172, v211, v172 quad_perm:[3,3,3,3] row_mask:0xf bank_mask:0xf
    v_add_f32_dpp v173, v215, v173 quad_perm:[3,3,3,3] row_mask:0xf bank_mask:0xf
    v_add_f32_dpp v174, v219, v174 quad_perm:[3,3,3,3] row_mask:0xf bank_mask:0xf
    v_add_f32_dpp v175, v223, v175 quad_perm:[3,3,3,3] row_mask:0xf bank_mask:0xf
    v_mov_b32_dpp v176, v224 quad_perm:[0,0,0,0] row_mask:0xf bank_mask:0xf
    v_mov_b32_dpp v177, v228 quad_perm:[0,0,0,0] row_mask:0xf bank_mask:0xf
    v_mov_b32_dpp v178, v232 quad_perm:[0,0,0,0] row_mask:0xf bank_mask:0xf
    v_mov_b32_dpp v179, v236 quad_perm:[0,0,0,0] row_mask:0xf bank_mask:0xf
    v_add_f32_dpp v176, v225, v176 quad_perm:[1,1,1,1] row_mask:0xf bank_mask:0xf
    v_add_f32_dpp v177, v229, v177 quad_perm:[1,1,1,1] row_mask:0xf bank_mask:0xf
    v_add_f32_dpp v178, v233, v178 quad_perm:[1,1,1,1] row_mask:0xf bank_mask:0xf
    v_add_f32_dpp v179, v237, v179 quad_perm:[1,1,1,1] row_mask:0xf bank_mask:0xf
    v_add_f32_dpp v176, v226, v176 quad_perm:[2,2,2,2] row_mask:0xf bank_mask:0xf
    v_add_f32_dpp v177, v230, v177 quad_perm:[2,2,2,2] row_mask:0xf bank_mask:0xf
    v_add_f32_dpp v178, v234, v178 quad_perm:[2,2,2,2] row_mask:0xf bank_mask:0xf
    v_add_f32_dpp v179, v238, v179 quad_perm:[2,2,2,2] row_mask:0xf bank_mask:0xf
    v_add_f32_dpp v176, v227, v176 quad_perm:[3,3,3,3] row_mask:0xf bank_mask:0xf
    v_add_f32_dpp v177, v231, v177 quad_perm:[3,3,3,3] row_mask:0xf bank_mask:0xf
    v_add_f32_dpp v178, v235, v178 quad_perm:[3,3,3,3] row_mask:0xf bank_mask:0xf
    v_add_f32_dpp v179, v239, v179 quad_perm:[3,3,3,3] row_mask:0xf bank_mask:0xf
    v_max3_f32 v14, v164, v165, v166
    v_max3_f32 v14, v14, v167, v168
    v_max3_f32 v14, v14, v169, v170
    v_max3_f32 v14, v14, v171, v172
    v_max3_f32 v14, v14, v173, v174
    v_max3_f32 v14, v14, v175, v176
    v_max3_f32 v14, v14, v177, v178
    v_max_f32 v14, v14, v179
    v_mov_b32 v10, v14
    s_nop 1
    v_permlane32_swap_b32 v14, v10
    s_nop 1
    v_max_f32 v14, v14, v10
    v_mov_b32 v10, v14
    s_nop 1
    v_permlane16_swap_b32 v14, v10
    s_nop 1
    v_max_f32 v14, v14, v10
    v_mul_f32 v14, s68, v14
    s_setpc_b64 s[4:5]
L_AV0:
    v_fma_f32 v24, v164, s68, -v14
    v_fma_f32 v25, v165, s68, -v14
    v_fma_f32 v26, v166, s68, -v14
    v_fma_f32 v27, v167, s68, -v14
    v_exp_f32 v24, v24
    v_exp_f32 v25, v25
    v_exp_f32 v26, v26
    v_exp_f32 v27, v27
    v_add_f32 v10, v24, v25
    v_add_f32 v15, v15, v26
    v_add_f32 v10, v10, v27
    v_cvt_pk_bf16_f32 v24, v24, v24
    v_cvt_pk_bf16_f32 v25, v25, v25
    v_cvt_pk_bf16_f32 v26, v26, v26
    v_cvt_pk_bf16_f32 v27, v27, v27
    v_add_f32 v15, v15, v10
    v_and_b32 v48, v24, v20
    v_and_b32 v49, v24, v21
    v_and_b32 v50, v24, v22
    v_and_b32 v51, v24, v23
    v_and_b32 v52, v25, v20
    v_and_b32 v53, v25, v21
    v_and_b32 v54, v25, v22
    v_and_b32 v55, v25, v23
    v_and_b32 v56, v26, v20
    v_and_b32 v57, v26, v21
    v_and_b32 v58, v26, v22
    v_and_b32 v59, v26, v23
    v_and_b32 v60, v27, v20
    v_and_b32 v61, v27, v21
    v_and_b32 v62, v27, v22
    v_and_b32 v63, v27, v23
    s_nop 1
    v_mfma_f32_16x16x32_bf16 v[36:39], v[48:51], v[96:99], v[36:39]
    v_mfma_f32_16x16x32_bf16 v[36:39], v[52:55], v[100:103], v[36:39]
    v_mfma_f32_16x16x32_bf16 v[36:39], v[56:59], v[104:107], v[36:39]
    v_mfma_f32_16x16x32_bf16 v[36:39], v[60:63], v[108:111], v[36:39]
    v_fma_f32 v24, v168, s68, -v14
    v_fma_f32 v25, v169, s68, -v14
    v_fma_f32 v26, v170, s68, -v14
    v_fma_f32 v27, v171, s68, -v14
    v_exp_f32 v24, v24
    v_exp_f32 v25, v25
    v_exp_f32 v26, v26
    v_exp_f32 v27, v27
    v_add_f32 v10, v24, v25
    v_add_f32 v15, v15, v26
    v_add_f32 v10, v10, v27
    v_cvt_pk_bf16_f32 v24, v24, v24
    v_cvt_pk_bf16_f32 v25, v25, v25
    v_cvt_pk_bf16_f32 v26, v26, v26
    v_cvt_pk_bf16_f32 v27, v27, v27
    v_add_f32 v15, v15, v10
    v_and_b32 v48, v24, v20
    v_and_b32 v49, v24, v21
    v_and_b32 v50, v24, v22
    v_and_b32 v51, v24, v23
    v_and_b32 v52, v25, v20
    v_and_b32 v53, v25, v21
    v_and_b32 v54, v25, v22
    v_and_b32 v55, v25, v23
    v_and_b32 v56, v26, v20
    v_and_b32 v57, v26, v21
    v_and_b32 v58, v26, v22
    v_and_b32 v59, v26, v23
    v_and_b32 v60, v27, v20
    v_and_b32 v61, v27, v21
    v_and_b32 v62, v27, v22
    v_and_b32 v63, v27, v23
    s_nop 1
    v_mfma_f32_16x16x32_bf16 v[36:39], v[48:51], v[112:115], v[36:39]
    v_mfma_f32_16x16x32_bf16 v[36:39], v[52:55], v[116:119], v[36:39]
    v_mfma_f32_16x16x32_bf16 v[36:39], v[56:59], v[120:123], v[36:39]
    v_mfma_f32_16x16x32_bf16 v[36:39], v[60:63], v[124:127], v[36:39]
    s_setpc_b64 s[4:5]
L_AV1:
    v_fma_f32 v24, v172, s68, -v14
    v_fma_f32 v25, v173, s68, -v14
    v_fma_f32 v26, v174, s68, -v14
    v_fma_f32 v27, v175, s68, -v14
    v_exp_f32 v24, v24
    v_exp_f32 v25, v25
    v_exp_f32 v26, v26
    v_exp_f32 v27, v27
    v_add_f32 v10, v24, v25
    v_add_f32 v15, v15, v26
    v_add_f32 v10, v10, v27
    v_cvt_pk_bf16_f32 v24, v24, v24
    v_cvt_pk_bf16_f32 v25, v25, v25
    v_cvt_pk_bf16_f32 v26, v26, v26
    v_cvt_pk_bf16_f32 v27, v27, v27
    v_add_f32 v15, v15, v10
    v_and_b32 v48, v24, v20
    v_and_b32 v49, v24, v21
    v_and_b32 v50, v24, v22
    v_and_b32 v51, v24, v23
    v_and_b32 v52, v25, v20
    v_and_b32 v53, v25, v21
    v_and_b32 v54, v25, v22
    v_and_b32 v55, v25, v23
    v_and_b32 v56, v26, v20
    v_and_b32 v57, v26, v21
    v_and_b32 v58, v26, v22
    v_and_b32 v59, v26, v23
    v_and_b32 v60, v27, v20
    v_and_b32 v61, v27, v21
    v_and_b32 v62, v27, v22
    v_and_b32 v63, v27, v23
    s_nop 1
    v_mfma_f32_16x16x32_bf16 v[36:39], v[48:51], v[128:131], v[36:39]
    v_mfma_f32_16x16x32_bf16 v[36:39], v[52:55], v[132:135], v[36:39]
    v_mfma_f32_16x16x32_bf16 v[36:39], v[56:59], v[136:139], v[36:39]
    v_mfma_f32_16x16x32_bf16 v[36:39], v[60:63], v[140:143], v[36:39]
    v_fma_f32 v24, v176, s68, -v14
    v_fma_f32 v25, v177, s68, -v14
    v_fma_f32 v26, v178, s68, -v14
    v_fma_f32 v27, v179, s68, -v14
    v_exp_f32 v24, v24
    v_exp_f32 v25, v25
    v_exp_f32 v26, v26
    v_exp_f32 v27, v27
    v_add_f32 v10, v24, v25
    v_add_f32 v15, v15, v26
    v_add_f32 v10, v10, v27
    v_cvt_pk_bf16_f32 v24, v24, v24
    v_cvt_pk_bf16_f32 v25, v25, v25
    v_cvt_pk_bf16_f32 v26, v26, v26
    v_cvt_pk_bf16_f32 v27, v27, v27
    v_add_f32 v15, v15, v10
    v_and_b32 v48, v24, v20
    v_and_b32 v49, v24, v21
    v_and_b32 v50, v24, v22
    v_and_b32 v51, v24, v23
    v_and_b32 v52, v25, v20
    v_and_b32 v53, v25, v21
    v_and_b32 v54, v25, v22
    v_and_b32 v55, v25, v23
    v_and_b32 v56, v26, v20
    v_and_b32 v57, v26, v21
    v_and_b32 v58, v26, v22
    v_and_b32 v59, v26, v23
    v_and_b32 v60, v27, v20
    v_and_b32 v61, v27, v21
    v_and_b32 v62, v27, v22
    v_and_b32 v63, v27, v23
    s_nop 1
    v_mfma_f32_16x16x32_bf16 v[36:39], v[48:51], v[144:147], v[36:39]
    v_mfma_f32_16x16x32_bf16 v[36:39], v[52:55], v[148:151], v[36:39]
    v_mfma_f32_16x16x32_bf16 v[36:39], v[56:59], v[152:155], v[36:39]
    v_mfma_f32_16x16x32_bf16 v[36:39], v[60:63], v[156:159], v[36:39]
    v_lshlrev_b32 v164, 4, v0
    v_add_u32 v164, 147456, v164
    s_lshl4_add_u32 s62, s3, 151808
    v_and_b32 v165, 8, v3
    v_add_u32 v165, s62, v165
    v_mov_b32 v10, v15
    s_nop 1
    v_permlane32_swap_b32 v15, v10
    s_nop 1
    v_add_f32 v15, v15, v10
    v_mov_b32 v10, v15
    s_nop 1
    v_permlane16_swap_b32 v15, v10
    s_nop 1
    v_add_f32 v15, v15, v10
    ds_write_b128 v164, v[36:39]
    ds_write_b64 v165, v[14:15]
    v_mov_b32 v164, 151940
    v_mov_b32 v165, 1
    s_mov_b64 exec, 1
    s_waitcnt lgkmcnt(0)
    ds_add_rtn_u32 v165, v164, v165
    s_mov_b64 exec, -1
    s_mul_i32 s62, s3, 272
    s_add_u32 s62, s62, 147456
    v_lshrrev_b32 v10, 1, v3
    v_lshl_add_u32 v204, v10, 5, s62
    v_and_b32 v10, 1, v3
    v_lshl_add_u32 v204, v10, 3, v204
    v_and_b32 v10, 1, v2
    v_lshl_add_u32 v204, v10, 2, v204
    s_lshl_b32 s62, s3, 4
    s_add_u32 s62, s62, 151808
    v_lshl_add_u32 v205, v2, 2, s62
    v_and_b32 v10, 3, v3
    v_mul_u32_u24 v206, 272, v10
    v_lshl_add_u32 v206, v2, 5, v206
    v_and_b32 v10, 4, v3
    v_lshl_add_u32 v206, v10, 2, v206
    v_bfe_i32 v10, v3, 2, 1
    v_and_b32 v183, 0xaaaaaaaa, v10
    v_or_b32 v183, 0x44444444, v183
    v_add_u32 v206, 147456, v206
    v_lshlrev_b32 v207, 2, v3
    v_add_u32 v207, 151808, v207
    s_waitcnt lgkmcnt(0)
    v_readfirstlane_b32 s62, v165
    v_lshlrev_b32 v164, 4, v1
    v_lshrrev_b32 v11, 5, v1
    v_add_u32 v10, 147456, v164
    v_lshlrev_b32 v165, 3, v11
    s_cmp_eq_u32 s62, 3
    s_cbranch_scc1 L_AM
    s_setpc_b64 s[4:5]
L_AM:
    v_add_u32 v165, 151808, v165
    ds_read_b64 v[168:169], v165 offset:0
    ds_read_b64 v[170:171], v165 offset:16
    ds_read_b64 v[172:173], v165 offset:32
    ds_read_b64 v[174:175], v165 offset:48
    ds_read_b128 v[208:211], v10 offset:0
    ds_read_b128 v[212:215], v10 offset:1024
    ds_read_b128 v[216:219], v10 offset:2048
    ds_read_b128 v[220:223], v10 offset:3072
    v_lshlrev_b32 v165, 4, v3
    v_lshl_add_u32 v165, v11, 6, v165
    s_mul_i32 s62, s74, 1024
    s_add_u32 s62, s62, 430080
    s_mul_i32 s63, s74, 128
    s_add_u32 s63, s63, 397312
    s_waitcnt lgkmcnt(4)
    v_max3_f32 v24, v168, v170, v172
    v_max_f32 v24, v24, v174
    v_sub_f32 v168, v168, v24
    v_sub_f32 v170, v170, v24
    v_sub_f32 v172, v172, v24
    v_sub_f32 v174, v174, v24
    v_exp_f32 v168, v168
    v_exp_f32 v170, v170
    v_exp_f32 v172, v172
    v_exp_f32 v174, v174
    v_xor_b32 v26, s7, v24
    v_mul_f32 v25, v168, v169
    v_fmac_f32 v25, v170, v171
    v_fmac_f32 v25, v172, v173
    v_fmac_f32 v25, v174, v175
    s_waitcnt lgkmcnt(0)
    v_mul_f32 v208, v168, v208
    v_mul_f32 v209, v168, v209
    v_mul_f32 v210, v168, v210
    v_mul_f32 v211, v168, v211
    v_xor_b32 v27, s7, v25
    v_fmac_f32 v208, v170, v212
    v_fmac_f32 v209, v170, v213
    v_fmac_f32 v210, v170, v214
    v_fmac_f32 v211, v170, v215
    v_fmac_f32 v208, v172, v216
    v_fmac_f32 v209, v172, v217
    v_fmac_f32 v210, v172, v218
    v_fmac_f32 v211, v172, v219
    v_fmac_f32 v208, v174, v220
    v_fmac_f32 v209, v174, v221
    v_fmac_f32 v210, v174, v222
    v_fmac_f32 v211, v174, v223
    v_cvt_pk_bf16_f32 v36, v208, v209
    v_cvt_pk_bf16_f32 v37, v210, v211
    v_xor_b32 v38, s7, v36
    v_xor_b32 v39, s7, v37
    buffer_store_dwordx4 v[36:39], v164, s[56:59], s62 offen sc1
    s_mov_b32 exec_lo, 15
    s_mov_b32 exec_hi, 15
    buffer_store_dwordx4 v[24:27], v165, s[56:59], s63 offen sc1
    s_mov_b64 exec, -1
    s_setpc_b64 s[4:5]
L_LA:
    v_xor_b32 v11, s7, v180
    v_ashrrev_i32 v180, 16, v180
    v_cmp_eq_u16 vcc, 0, v11
    v_cvt_f32_i32 v180, v180
    s_bcnt1_i32_b64 s62, vcc
    v_max_f32 v180, 0x44c80000, v180
    v_cndmask_b32 v180, 0, v180, vcc
    v_cvt_f32_u32 v11, s62
    s_cmp_lt_u32 s62, 24
    v_rcp_f32 v11, v11
    v_add_f32_dpp v180, v180, v180 row_ror:8 row_mask:0xf bank_mask:0xf
    s_nop 1
    v_add_f32_dpp v180, v180, v180 row_ror:4 row_mask:0xf bank_mask:0xf
    s_nop 1
    v_add_f32_dpp v180, v180, v180 row_ror:2 row_mask:0xf bank_mask:0xf
    s_nop 1
    v_add_f32_dpp v180, v180, v180 row_ror:1 row_mask:0xf bank_mask:0xf
    s_nop 1
    v_mov_b32 v10, v180
    s_nop 1
    v_permlane32_swap_b32 v180, v10
    s_nop 1
    v_add_f32 v180, v180, v10
    v_mov_b32 v10, v180
    s_nop 1
    v_permlane16_swap_b32 v180, v10
    s_nop 1
    v_add_f32 v180, v180, v10
    v_mul_f32 v180, v180, v11
    v_cvt_i32_f32 v180, v180
    s_nop 0
    v_readfirstlane_b32 s62, v180
    s_cbranch_scc1 L_LA1
    s_sub_i32 s62, s62, 1664
    s_max_i32 s62, s62, 0
    s_mul_i32 s62, s62, 6
    s_ashr_i32 s62, s62, 1
    s_min_i32 s62, s62, 1600
    s_sub_i32 s18, s18, s23
    s_add_i32 s18, s18, s62
    s_mov_b32 s23, s62
L_LA1:
    s_setpc_b64 s[4:5]
L_TR:
    v_mov_b32_dpp v12, v12 quad_perm:[0,0,0,0] row_mask:0xf bank_mask:0xf
    v_mov_b32 v10, v12
    s_nop 1
    v_permlane32_swap_b32 v12, v10
    s_nop 1
    v_max_f32 v12, v12, v10
    v_mov_b32 v10, v12
    s_nop 1
    v_permlane16_swap_b32 v12, v10
    s_nop 1
    v_max_f32 v12, v12, v10
    s_lshl2_add_u32 s62, s3, 151952
    v_mul_f32 v12, s68, v12
    v_mov_b32 v10, s62
    s_mov_b32 s67, 0
    s_add_i32 s18, s18, 240
    ds_write_b32 v10, v12
    s_setpc_b64 s[4:5]
L_T1:
    v_add_u32 v10, 0x10000, v8
    v_add_u32 v11, 0x20000, v8
    ds_read_b64_tr_b16 a[64:65], v8 offset:0
    ds_read_b64_tr_b16 a[66:67], v8 offset:2048
    ds_read_b64_tr_b16 a[68:69], v8 offset:4096
    ds_read_b64_tr_b16 a[70:71], v8 offset:6144
    ds_read_b64_tr_b16 a[72:73], v8 offset:8192
    ds_read_b64_tr_b16 a[74:75], v8 offset:10240
    ds_read_b64_tr_b16 a[76:77], v8 offset:12288
    ds_read_b64_tr_b16 a[78:79], v8 offset:14336
    ds_read_b64_tr_b16 a[80:81], v8 offset:16384
    ds_read_b64_tr_b16 a[82:83], v8 offset:18432
    ds_read_b64_tr_b16 a[84:85], v8 offset:20480
    ds_read_b64_tr_b16 a[86:87], v8 offset:22528
    ds_read_b64_tr_b16 a[88:89], v8 offset:24576
    ds_read_b64_tr_b16 a[90:91], v8 offset:26624
    ds_read_b64_tr_b16 a[92:93], v8 offset:28672
    ds_read_b64_tr_b16 a[94:95], v8 offset:30720
    ds_read_b64_tr_b16 a[96:97], v8 offset:32768
    ds_read_b64_tr_b16 a[98:99], v8 offset:34816
    ds_read_b64_tr_b16 a[100:101], v8 offset:36864
    ds_read_b64_tr_b16 a[102:103], v8 offset:38912
    ds_read_b64_tr_b16 a[104:105], v8 offset:40960
    ds_read_b64_tr_b16 a[106:107], v8 offset:43008
    ds_read_b64_tr_b16 a[108:109], v8 offset:45056
    ds_read_b64_tr_b16 a[110:111], v8 offset:47104
    ds_read_b64_tr_b16 a[112:113], v8 offset:49152
    ds_read_b64_tr_b16 a[114:115], v8 offset:51200
    ds_read_b64_tr_b16 a[116:117], v8 offset:53248
    ds_read_b64_tr_b16 a[118:119], v8 offset:55296
    ds_read_b64_tr_b16 a[120:121], v8 offset:57344
    ds_read_b64_tr_b16 a[122:123], v8 offset:59392
    ds_read_b64_tr_b16 a[124:125], v8 offset:61440
    ds_read_b64_tr_b16 a[126:127], v8 offset:63488
    ds_read_b64_tr_b16 a[128:129], v10 offset:0
    ds_read_b64_tr_b16 a[130:131], v10 offset:2048
    ds_read_b64_tr_b16 a[132:133], v10 offset:4096
    ds_read_b64_tr_b16 a[134:135], v10 offset:6144
    ds_read_b64_tr_b16 a[136:137], v10 offset:8192
    ds_read_b64_tr_b16 a[138:139], v10 offset:10240
    ds_read_b64_tr_b16 a[140:141], v10 offset:12288
    ds_read_b64_tr_b16 a[142:143], v10 offset:14336
    ds_read_b64_tr_b16 a[144:145], v10 offset:16384
    ds_read_b64_tr_b16 a[146:147], v10 offset:18432
    ds_read_b64_tr_b16 a[148:149], v10 offset:20480
    ds_read_b64_tr_b16 a[150:151], v10 offset:22528
    ds_read_b64_tr_b16 a[152:153], v10 offset:24576
    ds_read_b64_tr_b16 a[154:155], v10 offset:26624
    ds_read_b64_tr_b16 a[156:157], v10 offset:28672
    ds_read_b64_tr_b16 a[158:159], v10 offset:30720
    ds_read_b64_tr_b16 a[160:161], v10 offset:32768
    ds_read_b64_tr_b16 a[162:163], v10 offset:34816
    ds_read_b64_tr_b16 a[164:165], v10 offset:36864
    ds_read_b64_tr_b16 a[166:167], v10 offset:38912
    ds_read_b64_tr_b16 a[168:169], v10 offset:40960
    ds_read_b64_tr_b16 a[170:171], v10 offset:43008
    ds_read_b64_tr_b16 a[172:173], v10 offset:45056
    ds_read_b64_tr_b16 a[174:175], v10 offset:47104
    ds_read_b64_tr_b16 a[176:177], v10 offset:49152
    ds_read_b64_tr_b16 a[178:179], v10 offset:51200
    ds_read_b64_tr_b16 a[180:181], v10 offset:53248
    ds_read_b64_tr_b16 a[182:183], v10 offset:55296
    ds_read_b64_tr_b16 a[184:185], v10 offset:57344
    ds_read_b64_tr_b16 a[186:187], v10 offset:59392
    ds_read_b64_tr_b16 a[188:189], v10 offset:61440
    ds_read_b64_tr_b16 a[190:191], v10 offset:63488
    ds_read_b64_tr_b16 a[192:193], v11 offset:0
    ds_read_b64_tr_b16 a[194:195], v11 offset:2048
    ds_read_b64_tr_b16 a[196:197], v11 offset:4096
    ds_read_b64_tr_b16 a[198:199], v11 offset:6144
    ds_read_b64_tr_b16 a[200:201], v11 offset:8192
    ds_read_b64_tr_b16 a[202:203], v11 offset:10240
    ds_read_b64_tr_b16 a[204:205], v11 offset:12288
    ds_read_b64_tr_b16 a[206:207], v11 offset:14336
    v_mov_b64 v[208:209], 0
    v_mov_b64 v[210:211], 0
    v_mov_b64 v[212:213], 0
    v_mov_b64 v[214:215], 0
    v_mov_b64 v[216:217], 0
    v_mov_b64 v[218:219], 0
    v_mov_b64 v[220:221], 0
    v_mov_b64 v[222:223], 0
    v_mov_b64 v[224:225], 0
    v_mov_b64 v[226:227], 0
    v_mov_b64 v[228:229], 0
    v_mov_b64 v[230:231], 0
    v_mov_b64 v[232:233], 0
    v_mov_b64 v[234:235], 0
    v_mov_b64 v[236:237], 0
    v_mov_b64 v[238:239], 0
    v_mov_b64 v[240:241], 0
    v_mov_b64 v[242:243], 0
    s_waitcnt lgkmcnt(0)
L_ret:
    s_setpc_b64 s[4:5]
.section .rodata,"a"
.p2align 6
.amdhsa_kernel concat_heads__sliding_block_cached__mha_block_cached__decode_kernel
  .amdhsa_next_free_vgpr 512
  .amdhsa_next_free_sgpr 102
  .amdhsa_accum_offset 256
  .amdhsa_group_segment_fixed_size 0
  .amdhsa_kernarg_size 104
  .amdhsa_user_sgpr_count 2
  .amdhsa_user_sgpr_kernarg_segment_ptr 1
  .amdhsa_system_sgpr_workgroup_id_x 1
.end_amdhsa_kernel
```
